```python
import torch

def _softmax(x, axis=-1):
    return torch.softmax(x, dim=axis)

def _gelu(x):
    return torch.nn.functional.gelu(x, approximate='tanh')

def _silu(x):
    return torch.nn.functional.silu(x)

def _sigmoid(x):
    return torch.sigmoid(x)

def _layernorm(x, axis=-1, eps=1e-05):
    m = x.mean(dim=axis, keepdim=True)
    v = x.var(dim=axis, keepdim=True, unbiased=False)
    return (x - m) / torch.sqrt(v + eps)

def _scatter_add(tgt, idx, src, axis=0):
    return tgt.clone().index_add_(axis, idx, src)

def _segment_sum(src, seg, n):
    out = torch.zeros((n,) + src.shape[1:], dtype=src.dtype)
    return out.index_add_(0, seg, src)

def _pad(x, pw):
    flat = tuple((v for pair in reversed(pw) for v in pair))
    return torch.nn.functional.pad(x, flat)
kernel_name = 'standalone__tensor_product_equiv_mace__graph'

def setup_inputs():

    _w = lambda a: (lambda t: t.to(torch.bfloat16) if t.is_floating_point() else t)(torch.as_tensor(a))
    N, deg = (10000, 32)
    Lmax, C, De = (1, 128, 16)
    M = (Lmax + 1) ** 2
    E = N * deg
    src = (lambda lo, hi, *s: torch.randint(lo, hi, s))(0, N, E).to(torch.int64)
    dst = (lambda lo, hi, *s: torch.randint(lo, hi, s))(0, N, E).to(torch.int64)
    r = (lambda *s: torch.randn(*s, dtype=torch.bfloat16) * 0.05)(E, 3).to(float)
    r = r / (torch.linalg.norm(r, dim=-1, keepdim=True).to(float) + 1e-06)
    rx, ry, rz = (r[:, 0].clone(), r[:, 1].clone(), r[:, 2].clone())
    x2, y2, z2 = (rx * rx, ry * ry, rz * rz)
    sh_list = [torch.ones_like(rx), rx, ry, rz, rx * ry, ry * rz, 2.0 * z2 - x2 - y2, rx * rz, x2 - y2, ry * (3.0 * x2 - y2), rx * ry * rz, ry * (4.0 * z2 - x2 - y2), rz * (2.0 * z2 - 3.0 * x2 - 3.0 * y2), rx * (4.0 * z2 - x2 - y2), rz * (x2 - y2), rx * (x2 - 3.0 * y2)]
    sh16 = torch.stack(sh_list, dim=-1).to(float)
    pad = max(0, M - 16)
    sh_full = torch.cat([sh16, torch.zeros((E, pad), dtype=float)], dim=-1)[:, :M]
    cg = ((lambda *s: torch.randn(*s, dtype=torch.bfloat16) * 0.05)(M, M, M) * (1.0 / float(M))).to(float)
    return {'x': _w(((lambda *s: torch.randn(*s, dtype=torch.bfloat16) * 0.05)(N, M, C) * 0.3).to(float)), 'src': _w(src), 'dst': _w(dst), 'sh': _w(sh_full.to(float)), 'edge_attr': _w(((lambda *s: torch.randn(*s, dtype=torch.bfloat16) * 0.05)(E, De) * 0.3).to(float)), 'cg': _w(cg), 'w_r': _w(((lambda *s: torch.randn(*s, dtype=torch.bfloat16) * 0.05)(De, C) * (1.0 / float(De) ** 0.5)).to(float)), 'w_out': _w(((lambda *s: torch.randn(*s, dtype=torch.bfloat16) * 0.05)(C, C) * (1.0 / float(C) ** 0.5)).to(float))}

def reference(x, src, dst, sh, edge_attr, cg, w_r, w_out):
    N = x.shape[0]
    M = x.shape[1]
    C = x.shape[2]
    h = x[src]
    tp = torch.einsum('uvw,euc,ev->ewc', cg, h, sh)
    rw = edge_attr @ w_r
    msg = tp * rw[:, None, :]
    msg2 = msg.reshape(-1, M * C)
    agg = _segment_sum(msg2, dst, N).reshape(N, M, C)
    out = torch.einsum('nmc,cd->nmd', agg, w_out)
    return out
```

```asm
; @launch kernel=bin_kernel grid=(250,1,1) block=(768,1,1) lds=63488
; @launch kernel=main_kernel grid=(250,1,1) block=(512,1,1) lds=146560
.amdgcn_target "amdgcn-amd-amdhsa--gfx950"
.text
.globl bin_kernel
.p2align 8
.type bin_kernel,@function
bin_kernel:
    s_cmp_ge_u32 s2, 250
    s_cbranch_scc1 K1_end
    s_load_dwordx4 s[4:7], s[0:1], 8
    s_load_dwordx4 s[8:11], s[0:1], 24
    s_load_dwordx2 s[12:13], s[0:1], 80
    v_lshlrev_b32 v3, 3, v0
    v_lshrrev_b32 v1, 6, v0
    v_and_b32 v2, 63, v0
    v_lshlrev_b32 v5, 2, v0
    v_readfirstlane_b32 s3, v1
    v_mov_b32 v6, 0
    v_lshlrev_b32 v4, 4, v2
    v_lshlrev_b32 v70, 4, v0
    v_cmp_gt_u32 vcc, 256, v0
    s_and_saveexec_b64 s[14:15], vcc
    ds_write_b32 v5, v6 offset:0
    s_mov_b64 exec, s[14:15]
    s_mul_i32 s36, s2, 5120
    s_mov_b32 s22, 1280000
    s_mov_b32 s23, 0x00020000
    s_mov_b32 s18, 1280000
    s_mov_b32 s19, 0x00020000
    s_mov_b32 s40, 52429
    s_mov_b32 s41, 53688
    s_movk_i32 s42, -40
    v_mov_b32 v7, 1
    s_cmp_ge_u32 s3, 10
    s_waitcnt lgkmcnt(0)
    s_mov_b64 s[32:33], s[12:13]
    s_mov_b32 s34, 14434304
    s_mov_b32 s35, 0x00020000
    s_cbranch_scc1 K1_noedge
    s_mov_b64 s[20:21], s[6:7]
    buffer_load_dwordx2 v[10:11], v3, s[20:23], s36 offen nt
    s_mov_b64 s[16:17], s[4:5]
    buffer_load_dwordx2 v[12:13], v3, s[16:19], s36 offen nt
    s_mov_b64 s[24:25], s[8:9]
    s_mov_b32 s26, 2560000
    s_mov_b32 s27, 0x00020000
    s_mul_i32 s39, s2, 10240
    buffer_load_dwordx4 v[64:67], v70, s[24:27], s39 offen nt
    s_mov_b64 s[28:29], s[10:11]
    s_mov_b32 s30, 10240000
    s_mov_b32 s31, 0x00020000
    s_mul_i32 s37, s2, 40960
    s_lshl_b32 s38, s3, 12
    s_add_u32 s37, s37, s38
    s_add_u32 m0, s38, 22528
    s_nop 0
    buffer_load_dwordx4 v4, s[28:31], s37 offen offset:0 nt lds
    buffer_load_dwordx4 v4, s[28:31], s37 offen offset:1024 nt lds
    buffer_load_dwordx4 v4, s[28:31], s37 offen offset:2048 nt lds
    buffer_load_dwordx4 v4, s[28:31], s37 offen offset:3072 nt lds
    s_barrier
    s_waitcnt vmcnt(6)
    v_mul_u32_u24 v14, s40, v10
    v_lshrrev_b32 v14, 21, v14
    v_lshlrev_b32 v16, 2, v14
    ds_add_rtn_u32 v18, v16, v7 offset:0
    v_mul_u32_u24 v15, s40, v11
    v_lshrrev_b32 v15, 21, v15
    v_lshlrev_b32 v17, 2, v15
    ds_add_rtn_u32 v19, v17, v7 offset:0
    v_mad_i32_i24 v20, v14, s42, v10
    v_mad_i32_i24 v21, v15, s42, v11
    s_waitcnt vmcnt(5)
    v_mul_u32_u24 v22, s41, v12
    v_lshrrev_b32 v22, 26, v22
    v_lshl_or_b32 v22, v22, 16, v12
    v_lshl_or_b32 v22, v20, 19, v22
    v_mul_u32_u24 v23, s41, v13
    v_lshrrev_b32 v23, 26, v23
    v_lshl_or_b32 v23, v23, 16, v13
    v_lshl_or_b32 v23, v21, 19, v23
    s_waitcnt lgkmcnt(0)
    s_barrier
    ds_read_b128 v[24:27], v4 offset:0
    v_lshlrev_b32 v42, 1, v0
    v_or_b32 v43, 1, v42
    s_waitcnt lgkmcnt(0)
    v_add_u32 v28, v24, v25
    v_add3_u32 v28, v28, v26, v27
    v_mov_b32 v29, v28
    s_nop 1
    v_add_u32_dpp v29, v29, v29 row_shr:1 row_mask:0xf bank_mask:0xf bound_ctrl:0
    s_nop 1
    v_add_u32_dpp v29, v29, v29 row_shr:2 row_mask:0xf bank_mask:0xf bound_ctrl:0
    s_nop 1
    v_add_u32_dpp v29, v29, v29 row_shr:4 row_mask:0xf bank_mask:0xf bound_ctrl:0
    s_nop 1
    v_add_u32_dpp v29, v29, v29 row_shr:8 row_mask:0xf bank_mask:0xf bound_ctrl:0
    s_nop 1
    v_add_u32_dpp v29, v29, v29 row_bcast:15 row_mask:0xa bank_mask:0xf
    s_nop 1
    v_add_u32_dpp v29, v29, v29 row_bcast:31 row_mask:0xc bank_mask:0xf
    s_nop 1
    v_sub_u32 v30, v29, v28
    v_add_u32 v31, v30, v24
    v_add_u32 v32, v31, v25
    v_add_u32 v33, v32, v26
    ds_write_b128 v4, v[30:33] offset:1024
    s_cmp_lg_u32 s3, 0
    s_cbranch_scc1 K1_nohdr
    v_lshl_or_b32 v34, v24, 16, v30
    v_lshl_or_b32 v35, v25, 16, v31
    v_lshl_or_b32 v36, v26, 16, v32
    v_lshl_or_b32 v37, v27, 16, v33
    s_lshl_b32 s44, s2, 10
    buffer_store_dwordx4 v[34:37], v4, s[32:35], s44 offen
K1_nohdr:
    s_waitcnt lgkmcnt(0)
    ds_read_b32 v38, v16 offset:1024
    ds_read_b32 v39, v17 offset:1024
    s_waitcnt vmcnt(4) lgkmcnt(0)
    v_add_u32 v38, v38, v18
    v_mul_u32_u24 v44, 12, v38
    v_lshlrev_b32 v38, 2, v38
    ds_write_b32 v38, v42 offset:2048
    v_add_u32 v44, 7168, v44
    ds_write2_b32 v44, v64, v65 offset0:0 offset1:1
    ds_write_b32 v44, v22 offset:8
    v_add_u32 v39, v39, v19
    v_mul_u32_u24 v45, 12, v39
    v_lshlrev_b32 v39, 2, v39
    ds_write_b32 v39, v43 offset:2048
    v_add_u32 v45, 7168, v45
    ds_write2_b32 v45, v66, v67 offset0:0 offset1:1
    ds_write_b32 v45, v23 offset:8
    s_waitcnt lgkmcnt(0)
    s_branch K1_join
K1_noedge:
    s_cmp_lg_u32 s3, 11
    s_cbranch_scc1 K1_noimg
    s_cmp_ge_u32 s2, 38
    s_cbranch_scc1 K1_noimg
    s_load_dwordx4 s[52:55], s[0:1], 40
    s_load_dwordx2 s[56:57], s[0:1], 56
    s_lshl_b32 s58, s2, 10
    s_add_u32 s58, s58, 262144
    s_waitcnt lgkmcnt(0)
    s_cmp_ge_u32 s2, 36
    s_cbranch_scc1 K1_imgcg
    s_cmp_ge_u32 s2, 32
    s_cbranch_scc1 K1_imgwr
    s_mov_b64 s[60:61], s[56:57]
    s_mov_b32 s62, 32768
    s_mov_b32 s63, 0x00020000
    s_and_b32 s59, s2, 3
    s_lshl_b32 s59, s59, 4
    v_lshrrev_b32 v10, 4, v2
    v_lshlrev_b32 v10, 2, v10
    v_add_u32 v10, s59, v10
    v_lshlrev_b32 v10, 8, v10
    s_lshr_b32 s59, s2, 2
    s_lshl_b32 s59, s59, 5
    v_and_b32 v11, 15, v2
    v_lshl_add_u32 v10, v11, 1, v10
    v_add_u32 v10, s59, v10
    v_add_u32 v11, 16384, v10
    buffer_load_ushort v12, v10, s[60:63], 0 offen offset:0
    buffer_load_ushort v13, v11, s[60:63], 0 offen offset:0
    buffer_load_ushort v14, v10, s[60:63], 0 offen offset:256
    buffer_load_ushort v15, v11, s[60:63], 0 offen offset:256
    buffer_load_ushort v16, v10, s[60:63], 0 offen offset:512
    buffer_load_ushort v17, v11, s[60:63], 0 offen offset:512
    buffer_load_ushort v18, v10, s[60:63], 0 offen offset:768
    buffer_load_ushort v19, v11, s[60:63], 0 offen offset:768
    s_branch K1_imgpack
K1_imgwr:
    s_mov_b64 s[60:61], s[54:55]
    s_mov_b32 s62, 4096
    s_mov_b32 s63, 0x00020000
    s_and_b32 s59, s2, 1
    s_lshl_b32 s59, s59, 11
    s_bfe_u32 s64, s2, 0x10001
    s_lshl_b32 s64, s64, 7
    s_add_u32 s59, s59, s64
    v_lshlrev_b32 v10, 1, v2
    v_add_u32 v10, s59, v10
    buffer_load_ushort v12, v10, s[60:63], 0 offen offset:0
    buffer_load_ushort v13, v10, s[60:63], 0 offen offset:256
    buffer_load_ushort v14, v10, s[60:63], 0 offen offset:512
    buffer_load_ushort v15, v10, s[60:63], 0 offen offset:768
    buffer_load_ushort v16, v10, s[60:63], 0 offen offset:1024
    buffer_load_ushort v17, v10, s[60:63], 0 offen offset:1280
    buffer_load_ushort v18, v10, s[60:63], 0 offen offset:1536
    buffer_load_ushort v19, v10, s[60:63], 0 offen offset:1792
    s_branch K1_imgpack
K1_imgcg:
    s_mov_b64 s[60:61], s[52:53]
    s_mov_b32 s62, 128
    s_mov_b32 s63, 0x00020000
    s_and_b32 s59, s2, 1
    s_lshl_b32 s59, s59, 6
    v_and_b32 v10, 3, v2
    v_lshlrev_b32 v10, 1, v10
    v_add_u32 v10, s59, v10
    buffer_load_ushort v12, v10, s[60:63], 0 offen offset:0
    buffer_load_ushort v13, v10, s[60:63], 0 offen offset:8
    buffer_load_ushort v14, v10, s[60:63], 0 offen offset:16
    buffer_load_ushort v15, v10, s[60:63], 0 offen offset:24
    buffer_load_ushort v16, v10, s[60:63], 0 offen offset:32
    buffer_load_ushort v17, v10, s[60:63], 0 offen offset:40
    buffer_load_ushort v18, v10, s[60:63], 0 offen offset:48
    buffer_load_ushort v19, v10, s[60:63], 0 offen offset:56
K1_imgpack:
    s_waitcnt vmcnt(0)
    v_lshl_or_b32 v20, v13, 16, v12
    v_lshl_or_b32 v21, v15, 16, v14
    v_lshl_or_b32 v22, v17, 16, v16
    v_lshl_or_b32 v23, v19, 16, v18
    buffer_store_dwordx4 v[20:23], v4, s[32:35], s58 offen
K1_noimg:
    s_barrier
    s_barrier
K1_join:
    v_lshrrev_b32 v60, 1, v0
    v_lshlrev_b32 v60, 2, v60
    v_and_b32 v61, 1, v0
    v_lshlrev_b32 v61, 4, v61
    v_add_u32 v61, 22528, v61
    v_lshlrev_b32 v71, 4, v0
    s_mul_i32 s46, s2, 40960
    s_add_u32 s46, s46, 4194304
    s_mul_i32 s47, s2, 15360
    s_add_u32 s47, s47, 327680
    s_barrier
    ds_read_b128 v[72:75], v71 offset:7168
    ds_read_b128 v[108:111], v71 offset:19456
    ds_read_b32 v78, v60 offset:2048
    ds_read_b32 v79, v60 offset:3584
    ds_read_b32 v80, v60 offset:5120
    ds_read_b32 v81, v60 offset:6656
    s_waitcnt lgkmcnt(5)
    buffer_store_dwordx4 v[72:75], v71, s[32:35], s47 offen
    s_waitcnt lgkmcnt(4)
    v_add_u32 v76, 12288, v71
    v_cmpx_gt_u32 vcc, 192, v0
    buffer_store_dwordx4 v[108:111], v76, s[32:35], s47 offen
    s_mov_b64 exec, -1
    s_waitcnt lgkmcnt(0)
    v_lshl_add_u32 v78, v78, 5, v61
    v_lshl_add_u32 v79, v79, 5, v61
    v_lshl_add_u32 v80, v80, 5, v61
    v_lshl_add_u32 v81, v81, 5, v61
    s_waitcnt vmcnt(2)
    s_barrier
    ds_read_b128 v[88:91], v78
    ds_read_b128 v[92:95], v79
    ds_read_b128 v[96:99], v80
    v_cmpx_gt_u32 vcc, 256, v0
    ds_read_b128 v[100:103], v81
    s_mov_b64 exec, -1
    s_waitcnt lgkmcnt(3)
    buffer_store_dwordx4 v[88:91], v70, s[32:35], s46 offen nt
    v_add_u32 v70, 12288, v70
    s_waitcnt lgkmcnt(2)
    buffer_store_dwordx4 v[92:95], v70, s[32:35], s46 offen nt
    v_add_u32 v70, 12288, v70
    s_waitcnt lgkmcnt(1)
    buffer_store_dwordx4 v[96:99], v70, s[32:35], s46 offen nt
    v_add_u32 v70, 12288, v70
    s_waitcnt lgkmcnt(0)
    v_cmpx_gt_u32 vcc, 256, v0
    buffer_store_dwordx4 v[100:103], v70, s[32:35], s46 offen nt
    s_mov_b64 exec, -1
K1_end:
    s_endpgm
.globl main_kernel
.p2align 8
.type main_kernel,@function
main_kernel:
    s_cmp_ge_u32 s2, 250
    s_cbranch_scc1 K2_end
    s_load_dwordx2 s[6:7], s[0:1], 80
    s_load_dwordx2 s[4:5], s[0:1], 0
    s_load_dwordx4 s[68:71], s[0:1], 40
    s_load_dwordx4 s[72:75], s[0:1], 56
    v_lshrrev_b32 v108, 1, v0
    v_and_b32 v109, 1, v0
    v_lshlrev_b32 v11, 10, v108
    v_lshrrev_b32 v10, 6, v0
    v_and_b32 v1, 63, v0
    s_and_b32 s50, s2, 7
    s_mul_i32 s3, s50, 31
    s_min_u32 s50, s50, 2
    s_add_u32 s3, s3, s50
    s_lshr_b32 s50, s2, 3
    s_add_u32 s3, s3, s50
    s_lshl_b32 s51, s3, 2
    v_readfirstlane_b32 s24, v10
    s_mov_b32 s22, 256000
    s_mov_b32 s23, 0x00020000
    s_waitcnt lgkmcnt(0)
    s_mov_b64 s[20:21], s[6:7]
    buffer_load_dword v28, v11, s[20:23], s51 offen
    s_mov_b64 s[96:97], s[6:7]
    s_mov_b32 s98, 14434304
    s_mov_b32 s99, 0x00020000
    s_mov_b32 s22, 14434304
    s_lshl_b32 s25, s24, 13
    s_add_u32 s25, s25, 81024
    v_and_b32 v9, 15, v1
    v_lshlrev_b32 v204, 4, v1
    s_mov_b32 s51, 294912
    buffer_load_dwordx4 v[68:71], v204, s[96:99], s51 offen offset:0
    buffer_load_dwordx4 v[72:75], v204, s[96:99], s51 offen offset:1024
    buffer_load_dwordx4 v[76:79], v204, s[96:99], s51 offen offset:2048
    buffer_load_dwordx4 v[80:83], v204, s[96:99], s51 offen offset:3072
    s_mov_b32 s51, 299008
    buffer_load_dwordx4 v[84:87], v204, s[96:99], s51 offen offset:0
    buffer_load_dwordx4 v[88:91], v204, s[96:99], s51 offen offset:1024
    s_mov_b32 s82, 0
    s_mov_b64 s[8:9], s[4:5]
    s_mov_b32 s10, 10240000
    s_mov_b32 s11, 0x00020000
    s_mov_b64 s[16:17], s[74:75]
    s_mov_b32 s18, 10240000
    s_mov_b32 s19, 0x00020000
    s_mov_b32 s30, 0
    v_lshlrev_b32 v12, 2, v0
    v_mov_b32 v13, 0
    v_cmp_gt_u32 vcc, 320, v0
    s_and_saveexec_b64 s[58:59], vcc
    ds_write_b32 v12, v13 offset:16384
    v_cmpx_gt_u32 vcc, 16, v0
    ds_write_b32 v12, v13 offset:19008
    s_mov_b64 exec, s[58:59]
    v_bfe_u32 v12, v1, 2, 2
    v_lshrrev_b32 v13, 4, v1
    v_and_b32 v15, 3, v1
    v_lshlrev_b32 v2, 8, v12
    v_lshl_add_u32 v2, v13, 6, v2
    v_lshl_add_u32 v2, v15, 4, v2
    v_lshrrev_b32 v10, 5, v1
    v_lshlrev_b32 v3, 8, v10
    v_lshl_add_u32 v3, v12, 6, v3
    v_bfe_u32 v10, v1, 4, 1
    v_lshl_add_u32 v3, v10, 5, v3
    v_lshl_add_u32 v3, v15, 3, v3
    v_add_u32 v3, s25, v3
    v_lshrrev_b32 v7, 2, v1
    v_lshl_add_u32 v8, v13, 2, v15
    v_lshlrev_b32 v202, 3, v12
    v_add_u32 v202, 31872, v202
    s_mov_b32 s66, 0xfffffc00
    v_mov_b32 v14, 0x7ffffc00
    s_lshl_b32 s26, s24, 8
    s_lshl_b32 s81, s24, 11
    s_add_u32 s81, s81, 0
    v_mov_b32 v124, 0
    v_mov_b32 v125, 0
    v_mov_b32 v126, 0
    v_mov_b32 v127, 0
    v_mov_b32 v128, 0
    v_mov_b32 v129, 0
    v_mov_b32 v130, 0
    v_mov_b32 v131, 0
    v_mov_b32 v132, 0
    v_mov_b32 v133, 0
    v_mov_b32 v134, 0
    v_mov_b32 v135, 0
    v_mov_b32 v136, 0
    v_mov_b32 v137, 0
    v_mov_b32 v138, 0
    v_mov_b32 v139, 0
    v_mov_b32 v140, 0
    v_mov_b32 v141, 0
    v_mov_b32 v142, 0
    v_mov_b32 v143, 0
    v_mov_b32 v144, 0
    v_mov_b32 v145, 0
    v_mov_b32 v146, 0
    v_mov_b32 v147, 0
    v_mov_b32 v148, 0
    v_mov_b32 v149, 0
    v_mov_b32 v150, 0
    v_mov_b32 v151, 0
    v_mov_b32 v152, 0
    v_mov_b32 v153, 0
    v_mov_b32 v154, 0
    v_mov_b32 v155, 0
    v_mov_b32 v156, 0
    v_mov_b32 v157, 0
    v_mov_b32 v158, 0
    v_mov_b32 v159, 0
    v_mov_b32 v160, 0
    v_mov_b32 v161, 0
    v_mov_b32 v162, 0
    v_mov_b32 v163, 0
    v_mov_b32 v92, 1
    v_mul_u32_u24 v108, 1280, v108
    v_sub_u32 v110, v109, v92
    s_waitcnt lgkmcnt(0)
    s_barrier
    s_waitcnt vmcnt(6)
    v_lshrrev_b32 v112, 16, v28
    v_and_b32 v111, 0xffff, v28
    v_and_b32 v113, v112, v110
    v_cmp_lt_u32 vcc, 24, v112
    v_add_u32 v111, v111, v108
    v_add_u32_dpp v113, v113, v113 row_shr:1 row_mask:0xf bank_mask:0xf bound_ctrl:0
    s_nop 1
    v_add_u32_dpp v113, v113, v113 row_shr:2 row_mask:0xf bank_mask:0xf bound_ctrl:0
    s_nop 1
    v_add_u32_dpp v113, v113, v113 row_shr:4 row_mask:0xf bank_mask:0xf bound_ctrl:0
    s_nop 1
    v_add_u32_dpp v113, v113, v113 row_shr:8 row_mask:0xf bank_mask:0xf bound_ctrl:0
    s_nop 1
    v_add_u32_dpp v113, v113, v113 row_bcast:15 row_mask:0xa bank_mask:0xf
    s_nop 1
    v_add_u32_dpp v113, v113, v113 row_bcast:31 row_mask:0xc bank_mask:0xf
    s_nop 1
    s_or_b32 s50, vcc_lo, vcc_hi
    v_readlane_b32 s67, v113, 63
    v_sub_u32 v113, v113, v112
    v_sub_u32 v111, v111, v113
    v_add_u32 v113, v113, v109
    v_lshl_add_u32 v113, v113, 2, s81
    v_sub_u32 v112, v112, v109
    s_cmp_gt_u32 s67, 256
    s_cselect_b32 s50, 1, s50
    s_cmp_lg_u32 s50, 0
    s_cbranch_scc1 K2_setflag
    v_cmpx_lt_i32 vcc, 0, v112
    s_cbranch_execz K2_cdone
    ds_write_b32 v113, v111 offset:0
    v_cmpx_lt_i32 vcc, 2, v112
    s_cbranch_execz K2_cdone
    ds_write_b32 v113, v111 offset:8
    v_cmpx_lt_i32 vcc, 4, v112
    s_cbranch_execz K2_cdone
    ds_write_b32 v113, v111 offset:16
    v_cmpx_lt_i32 vcc, 6, v112
    s_cbranch_execz K2_cdone
    ds_write_b32 v113, v111 offset:24
    v_cmpx_lt_i32 vcc, 8, v112
    s_cbranch_execz K2_cdone
    ds_write_b32 v113, v111 offset:32
    v_cmpx_lt_i32 vcc, 10, v112
    s_cbranch_execz K2_cdone
    ds_write_b32 v113, v111 offset:40
    v_cmpx_lt_i32 vcc, 12, v112
    s_cbranch_execz K2_cdone
    ds_write_b32 v113, v111 offset:48
    v_cmpx_lt_i32 vcc, 14, v112
    s_cbranch_execz K2_cdone
    ds_write_b32 v113, v111 offset:56
    v_cmpx_lt_i32 vcc, 16, v112
    s_cbranch_execz K2_cdone
    ds_write_b32 v113, v111 offset:64
    v_cmpx_lt_i32 vcc, 18, v112
    s_cbranch_execz K2_cdone
    ds_write_b32 v113, v111 offset:72
    v_cmpx_lt_i32 vcc, 20, v112
    s_cbranch_execz K2_cdone
    ds_write_b32 v113, v111 offset:80
    v_cmpx_lt_i32 vcc, 22, v112
    s_cbranch_execz K2_cdone
    ds_write_b32 v113, v111 offset:88
K2_cdone:
    s_mov_b64 exec, -1
K2_round:
    v_lshl_add_u32 v10, v1, 2, s81
    v_mov_b32 v11, s24
    v_lshlrev_b32 v11, 2, v11
    v_mov_b32 v12, s67
    ds_write_b32 v11, v12 offset:18944
    v_sub_u32 v93, s67, v1
    s_lshl_b32 s50, s67, 1
    v_sub_u32 v123, s50, v1
    v_lshrrev_b32 v13, 1, v1
    v_lshl_add_u32 v13, v13, 2, s81
    s_waitcnt lgkmcnt(0)
    ds_read_b32 v28, v10 offset:0
    ds_read_b32 v29, v10 offset:256
    ds_read_b32 v30, v10 offset:512
    ds_read_b32 v31, v10 offset:768
    ds_read_b32 v52, v13 offset:0
    ds_read_b32 v53, v13 offset:128
    ds_read_b32 v54, v13 offset:256
    ds_read_b32 v55, v13 offset:384
    ds_read_b32 v56, v13 offset:512
    ds_read_b32 v57, v13 offset:640
    ds_read_b32 v58, v13 offset:768
    ds_read_b32 v59, v13 offset:896
    s_waitcnt lgkmcnt(8)
    s_cmp_lg_u32 s30, 0
    s_cbranch_scc1 K2_toB1
    v_add_u32 v28, v28, v1
    v_mul_u32_u24 v28, 12, v28
    v_add_u32 v29, v29, v1
    v_add_u32 v29, 64, v29
    v_mul_u32_u24 v29, 12, v29
    v_add_u32 v30, v30, v1
    v_add_u32 v30, 128, v30
    v_mul_u32_u24 v30, 12, v30
    v_add_u32 v31, v31, v1
    v_add_u32 v31, 192, v31
    v_mul_u32_u24 v31, 12, v31
    s_mov_b32 s50, 327680
    v_cmpx_lt_i32 vcc, 0, v93
    s_cbranch_execz K2_kdone
    buffer_load_dwordx3 v[36:38], v28, s[96:99], s50 offen
    v_cmpx_lt_i32 vcc, 64, v93
    s_cbranch_execz K2_kdone
    buffer_load_dwordx3 v[40:42], v29, s[96:99], s50 offen
    v_cmpx_lt_i32 vcc, 128, v93
    s_cbranch_execz K2_kdone
    buffer_load_dwordx3 v[44:46], v30, s[96:99], s50 offen
    v_cmpx_lt_i32 vcc, 192, v93
    s_cbranch_execz K2_kdone
    buffer_load_dwordx3 v[48:50], v31, s[96:99], s50 offen
K2_kdone:
    s_mov_b64 exec, -1
    s_branch K2_toB1
K2_setflag:
    v_mov_b32 v11, s24
    v_lshlrev_b32 v11, 2, v11
    v_mov_b32 v12, 0x10000
    ds_write_b32 v11, v12 offset:18944
K2_toB1:
    s_waitcnt lgkmcnt(0)
    s_barrier
    v_lshlrev_b32 v10, 2, v1
    ds_read_b32 v108, v10 offset:18944
    v_lshlrev_b32 v13, 4, v1
    v_lshl_add_u32 v52, v52, 5, v13
    v_lshl_add_u32 v53, v53, 5, v13
    v_lshl_add_u32 v54, v54, 5, v13
    v_lshl_add_u32 v55, v55, 5, v13
    v_lshl_add_u32 v56, v56, 5, v13
    v_lshl_add_u32 v57, v57, 5, v13
    v_lshl_add_u32 v58, v58, 5, v13
    v_lshl_add_u32 v59, v59, 5, v13
    s_waitcnt lgkmcnt(0)
    v_mov_b32 v109, v108
    s_nop 1
    v_add_u32_dpp v109, v109, v109 row_shr:1 row_mask:0xf bank_mask:0xf bound_ctrl:0
    s_nop 1
    v_add_u32_dpp v109, v109, v109 row_shr:2 row_mask:0xf bank_mask:0xf bound_ctrl:0
    s_nop 1
    v_add_u32_dpp v109, v109, v109 row_shr:4 row_mask:0xf bank_mask:0xf bound_ctrl:0
    s_nop 1
    v_sub_u32 v108, v109, v108
    v_readlane_b32 s52, v109, 7
    v_readlane_b32 s83, v108, s24
    s_cmp_gt_u32 s52, 1536
    s_cbranch_scc1 K2_slow
    s_lshl_b32 s50, s83, 5
    s_add_u32 s50, s50, 31872
    s_cmp_lg_u32 s30, 0
    s_cbranch_scc1 K2_slowpay
    s_mov_b32 s51, 4194304
    s_mov_b32 m0, s50
    v_cmpx_lt_i32 vcc, 0, v123
    s_cbranch_execz K2_pd0
    buffer_load_dwordx4 v52, s[96:99], s51 offen offset:0 lds
    v_cmpx_lt_i32 vcc, 64, v123
    s_cbranch_execz K2_pd1
    buffer_load_dwordx4 v53, s[96:99], s51 offen offset:1024 lds
    v_cmpx_lt_i32 vcc, 128, v123
    s_cbranch_execz K2_pd2
    buffer_load_dwordx4 v54, s[96:99], s51 offen offset:2048 lds
    v_cmpx_lt_i32 vcc, 192, v123
    s_cbranch_execz K2_pd3
    buffer_load_dwordx4 v55, s[96:99], s51 offen offset:3072 lds
    s_add_u32 m0, s50, 4096
    s_add_u32 s51, s51, 4096
    v_cmpx_lt_i32 vcc, 256, v123
    s_cbranch_execz K2_pd4
    buffer_load_dwordx4 v56, s[96:99], s51 offen offset:0 lds
    v_cmpx_lt_i32 vcc, 320, v123
    s_cbranch_execz K2_pd5
    buffer_load_dwordx4 v57, s[96:99], s51 offen offset:1024 lds
    v_cmpx_lt_i32 vcc, 384, v123
    s_cbranch_execz K2_pd6
    buffer_load_dwordx4 v58, s[96:99], s51 offen offset:2048 lds
    v_cmpx_lt_i32 vcc, 448, v123
    s_cbranch_execz K2_pd7
    buffer_load_dwordx4 v59, s[96:99], s51 offen offset:3072 lds
    s_waitcnt vmcnt(8)
    s_branch K2_pdone
K2_pd0:
    s_waitcnt vmcnt(0)
    s_branch K2_pdone
K2_pd1:
    s_waitcnt vmcnt(1)
    s_branch K2_pdone
K2_pd2:
    s_waitcnt vmcnt(2)
    s_branch K2_pdone
K2_pd3:
    s_waitcnt vmcnt(3)
    s_branch K2_pdone
K2_pd4:
    s_waitcnt vmcnt(4)
    s_branch K2_pdone
K2_pd5:
    s_waitcnt vmcnt(5)
    s_branch K2_pdone
K2_pd6:
    s_waitcnt vmcnt(6)
    s_branch K2_pdone
K2_pd7:
    s_waitcnt vmcnt(7)
    s_branch K2_pdone
K2_slowpay:
    v_add_u32 v28, v28, v1
    v_lshlrev_b32 v29, 5, v28
    v_lshlrev_b32 v30, 3, v28
    v_lshl_add_u32 v31, v1, 2, s81
    ds_read_b32 v38, v31 offset:1024
    buffer_load_dwordx4 v[52:55], v29, s[96:99], 0 offen
    buffer_load_dwordx4 v[56:59], v29, s[96:99], 0 offen offset:16
    buffer_load_dwordx2 v[36:37], v30, s[20:23], 0 offen
    v_lshl_add_u32 v31, v1, 5, s50
    s_waitcnt vmcnt(0) lgkmcnt(0)
    v_cmpx_lt_i32 vcc, 0, v93
    ds_write_b128 v31, v[52:55]
    ds_write_b128 v31, v[56:59] offset:16
K2_pdone:
    s_mov_b64 exec, -1
    v_add_u32 v10, s83, v1
    v_lshlrev_b32 v10, 3, v10
    v_cmpx_lt_i32 vcc, 0, v93
    s_cbranch_execz K2_hdone
    v_lshrrev_b32 v60, 14, v38
    ds_add_rtn_u32 v64, v60, v92 offset:16384
    ds_write_b64 v10, v[36:37] offset:19584
    v_cmpx_lt_i32 vcc, 64, v93
    s_cbranch_execz K2_hdone
    v_lshrrev_b32 v61, 14, v42
    ds_add_rtn_u32 v65, v61, v92 offset:16384
    ds_write_b64 v10, v[40:41] offset:20096
    v_cmpx_lt_i32 vcc, 128, v93
    s_cbranch_execz K2_hdone
    v_lshrrev_b32 v62, 14, v46
    ds_add_rtn_u32 v66, v62, v92 offset:16384
    ds_write_b64 v10, v[44:45] offset:20608
    v_cmpx_lt_i32 vcc, 192, v93
    s_cbranch_execz K2_hdone
    v_lshrrev_b32 v63, 14, v50
    ds_add_rtn_u32 v67, v63, v92 offset:16384
    ds_write_b64 v10, v[48:49] offset:21120
K2_hdone:
    s_mov_b64 exec, -1
    v_lshlrev_b32 v11, 5, v1
    s_waitcnt lgkmcnt(0)
    s_barrier
    ds_read_b128 v[94:97], v11 offset:16384
    ds_read_b128 v[98:101], v11 offset:16400
    s_waitcnt lgkmcnt(0)
    s_cmp_lg_u32 s30, 0
    s_cbranch_scc1 K2_static
    v_add_u32 v94, v94, v98
    v_add_u32 v95, v95, v99
    v_add3_u32 v94, v94, v96, v100
    v_add3_u32 v95, v95, v97, v101
    v_add_u32 v94, v94, v95
    v_sub_u32 v95, 63, v1
    v_cmp_gt_u32 vcc, 40, v1
    v_lshl_or_b32 v94, v94, 6, v95
    s_mul_i32 s50, s24, 5
    v_cndmask_b32 v94, 0, v94, vcc
    s_add_u32 s51, s50, 0
    v_readlane_b32 s32, v94, s51
    s_add_u32 s51, s50, 1
    v_readlane_b32 s33, v94, s51
    s_add_u32 s51, s50, 2
    v_readlane_b32 s34, v94, s51
    s_add_u32 s51, s50, 3
    v_readlane_b32 s35, v94, s51
    s_add_u32 s51, s50, 4
    v_readlane_b32 s36, v94, s51
    v_cmp_lt_u32 s[38:39], s32, v94
    v_cmp_lt_u32 s[40:41], s33, v94
    v_cmp_lt_u32 s[42:43], s34, v94
    v_cmp_lt_u32 s[44:45], s35, v94
    v_cmp_lt_u32 s[46:47], s36, v94
    s_bcnt1_i32_b64 s32, s[38:39]
    v_writelane_b32 v111, s32, 0
    s_bcnt1_i32_b64 s33, s[40:41]
    v_writelane_b32 v111, s33, 1
    s_bcnt1_i32_b64 s34, s[42:43]
    v_writelane_b32 v111, s34, 2
    s_bcnt1_i32_b64 s35, s[44:45]
    v_writelane_b32 v111, s35, 3
    s_bcnt1_i32_b64 s36, s[46:47]
    v_writelane_b32 v111, s36, 4
    v_lshrrev_b32 v112, 3, v111
    v_and_b32 v113, 1, v112
    v_mul_u32_u24 v113, 7, v113
    v_xor_b32 v113, v113, v111
    v_and_b32 v113, 7, v113
    v_lshl_add_u32 v113, v113, 3, v112
    v_lshlrev_b32 v113, 2, v113
    v_add_u32 v114, s50, v1
    s_mov_b64 exec, 0x1f
    ds_write_b32 v113, v114 offset:19072
    s_mov_b64 exec, -1
    s_lshl_b32 s50, s24, 5
    v_lshl_add_u32 v113, v1, 2, s50
    s_waitcnt lgkmcnt(0)
    s_barrier
    ds_read_b32 v114, v113 offset:19072
    s_waitcnt lgkmcnt(0)
    v_readlane_b32 s76, v114, 0
    v_readlane_b32 s77, v114, 1
    v_readlane_b32 s78, v114, 2
    v_readlane_b32 s79, v114, 3
    v_readlane_b32 s80, v114, 4
    s_branch K2_assigned
K2_static:
    s_add_u32 s76, s24, 0
    s_add_u32 s77, s24, 8
    s_add_u32 s78, s24, 16
    s_add_u32 s79, s24, 24
    s_add_u32 s80, s24, 32
    v_lshl_add_u32 v114, v1, 3, s24
    s_lshl_b32 s50, s24, 5
    v_lshl_add_u32 v113, v1, 2, s50
    s_mov_b64 exec, 0x1f
    ds_write_b32 v113, v114 offset:19072
    s_mov_b64 exec, -1
K2_assigned:
    v_lshlrev_b32 v113, 2, v114
    v_mul_u32_u24 v115, 1280, v1
    v_add_u32 v115, s25, v115
    v_and_b32 v116, 3, v114
    v_lshl_add_u32 v115, v116, 6, v115
    s_mov_b64 exec, 0x1f
    ds_write_b32 v113, v115 offset:19328
    s_mov_b64 exec, -1
    v_lshlrev_b32 v10, 2, v1
    s_lshl_b32 s50, s76, 5
    v_add_u32 v94, s50, v10
    ds_read_b32 v108, v94 offset:16384
    s_lshl_b32 s51, s77, 5
    v_add_u32 v95, s51, v10
    ds_read_b32 v109, v95 offset:16384
    s_lshl_b32 s52, s78, 5
    v_add_u32 v96, s52, v10
    ds_read_b32 v110, v96 offset:16384
    s_lshl_b32 s53, s79, 5
    v_add_u32 v97, s53, v10
    ds_read_b32 v111, v97 offset:16384
    s_lshl_b32 s54, s80, 5
    v_add_u32 v98, s54, v10
    ds_read_b32 v112, v98 offset:16384
    s_waitcnt lgkmcnt(0)
    v_add3_u32 v113, v108, v109, v110
    v_add3_u32 v113, v113, v111, v112
    v_mov_b32 v114, v113
    s_nop 1
    v_add_u32_dpp v114, v114, v114 row_shr:1 row_mask:0xf bank_mask:0xf bound_ctrl:0
    s_nop 1
    v_add_u32_dpp v114, v114, v114 row_shr:2 row_mask:0xf bank_mask:0xf bound_ctrl:0
    s_nop 1
    v_add_u32_dpp v114, v114, v114 row_shr:4 row_mask:0xf bank_mask:0xf bound_ctrl:0
    s_nop 1
    v_sub_u32 v113, v114, v113
    v_readlane_b32 s27, v114, 7
    v_add_u32 v113, s26, v113
    s_mov_b64 exec, 0xff
    ds_write_b32 v94, v113 offset:17664
    v_add_u32 v113, v113, v108
    v_or_b32 v114, 524288, v113
    ds_write_b32 v95, v114 offset:17664
    v_add_u32 v113, v113, v109
    v_or_b32 v114, 1048576, v113
    ds_write_b32 v96, v114 offset:17664
    v_add_u32 v113, v113, v110
    v_or_b32 v114, 1572864, v113
    ds_write_b32 v97, v114 offset:17664
    v_add_u32 v113, v113, v111
    v_or_b32 v114, 2097152, v113
    ds_write_b32 v98, v114 offset:17664
    s_mov_b64 exec, -1
    s_cmp_le_u32 s27, 256
    s_cbranch_scc1 K2_cntok
    v_mov_b32 v10, 19008
    ds_write_b32 v10, v92
K2_cntok:
    s_waitcnt lgkmcnt(0)
    s_barrier
    v_mov_b32 v11, 19008
    ds_read_b32 v108, v11
    ds_read_b32 v102, v60 offset:17664
    ds_read_b32 v103, v61 offset:17664
    ds_read_b32 v104, v62 offset:17664
    ds_read_b32 v105, v63 offset:17664
    v_add_u32 v109, s83, v1
    s_waitcnt lgkmcnt(0)
    v_readfirstlane_b32 s50, v108
    s_cmp_lg_u32 s50, 0
    s_cbranch_scc1 K2_slow
    v_cmpx_lt_i32 vcc, 0, v93
    s_cbranch_execz K2_sdone
    v_and_b32 v11, 0xffff, v102
    v_add_lshl_u32 v11, v11, v64, 3
    v_and_b32 v12, 0x3fff, v38
    v_lshlrev_b32 v12, 10, v12
    v_lshrrev_b32 v13, 16, v102
    v_or_b32 v110, v13, v12
    v_add_u32 v111, 0, v109
    ds_write_b64 v11, v[110:111] offset:0
    v_cmpx_lt_i32 vcc, 64, v93
    s_cbranch_execz K2_sdone
    v_and_b32 v11, 0xffff, v103
    v_add_lshl_u32 v11, v11, v65, 3
    v_and_b32 v12, 0x3fff, v42
    v_lshlrev_b32 v12, 10, v12
    v_lshrrev_b32 v13, 16, v103
    v_or_b32 v112, v13, v12
    v_add_u32 v113, 64, v109
    ds_write_b64 v11, v[112:113] offset:0
    v_cmpx_lt_i32 vcc, 128, v93
    s_cbranch_execz K2_sdone
    v_and_b32 v11, 0xffff, v104
    v_add_lshl_u32 v11, v11, v66, 3
    v_and_b32 v12, 0x3fff, v46
    v_lshlrev_b32 v12, 10, v12
    v_lshrrev_b32 v13, 16, v104
    v_or_b32 v110, v13, v12
    v_add_u32 v111, 128, v109
    ds_write_b64 v11, v[110:111] offset:0
    v_cmpx_lt_i32 vcc, 192, v93
    s_cbranch_execz K2_sdone
    v_and_b32 v11, 0xffff, v105
    v_add_lshl_u32 v11, v11, v67, 3
    v_and_b32 v12, 0x3fff, v50
    v_lshlrev_b32 v12, 10, v12
    v_lshrrev_b32 v13, 16, v105
    v_or_b32 v112, v13, v12
    v_add_u32 v113, 192, v109
    ds_write_b64 v11, v[112:113] offset:0
K2_sdone:
    s_mov_b64 exec, -1
    v_add_u32 v4, s26, v9
    v_lshlrev_b32 v4, 3, v4
    v_add_u32 v5, s26, v7
    v_lshlrev_b32 v5, 3, v5
    v_add_u32 v6, s26, v8
    v_lshlrev_b32 v6, 3, v6
    s_mov_b32 s28, s27
    s_waitcnt lgkmcnt(0)
    s_barrier
    s_cmp_eq_u32 s28, 0
    s_cbranch_scc1 K2_b4only
    ds_read_b32 v16, v4 offset:0
    v_add_u32 v4, 128, v4
    ds_read_b32 v200, v5 offset:4
    ds_read_b32 v201, v6 offset:4
    v_add_u32 v5, 128, v5
    v_add_u32 v6, 128, v6
    v_cmp_gt_i32 s[60:61], s28, v9
    v_cmp_gt_i32 s[62:63], s28, v7
    v_cmp_gt_i32 s[64:65], s28, v8
    s_waitcnt lgkmcnt(2)
    v_cndmask_b32 v16, v14, v16, s[60:61]
    s_nop 0
    v_readlane_b32 s32, v16, 0
    s_add_u32 m0, s25, 0
    s_and_b32 s48, s32, s66
    buffer_load_dwordx4 v2, s[8:11], s48 offen lds
    v_readlane_b32 s33, v16, 1
    s_add_u32 m0, s25, 1024
    s_and_b32 s49, s33, s66
    buffer_load_dwordx4 v2, s[8:11], s49 offen lds
    v_readlane_b32 s34, v16, 2
    s_add_u32 m0, s25, 2048
    s_and_b32 s48, s34, s66
    buffer_load_dwordx4 v2, s[8:11], s48 offen lds
    v_readlane_b32 s35, v16, 3
    s_add_u32 m0, s25, 3072
    s_and_b32 s49, s35, s66
    buffer_load_dwordx4 v2, s[8:11], s49 offen lds
    v_readlane_b32 s36, v16, 4
    s_add_u32 m0, s25, 4096
    s_and_b32 s48, s36, s66
    buffer_load_dwordx4 v2, s[8:11], s48 offen lds
    v_readlane_b32 s37, v16, 5
    s_add_u32 m0, s25, 5120
    s_and_b32 s49, s37, s66
    buffer_load_dwordx4 v2, s[8:11], s49 offen lds
    v_readlane_b32 s38, v16, 6
    s_add_u32 m0, s25, 6144
    s_and_b32 s48, s38, s66
    buffer_load_dwordx4 v2, s[8:11], s48 offen lds
    v_readlane_b32 s39, v16, 7
    s_add_u32 m0, s25, 7168
    s_and_b32 s49, s39, s66
    buffer_load_dwordx4 v2, s[8:11], s49 offen lds
    s_waitcnt lgkmcnt(0)
    v_lshlrev_b32 v200, 3, v200
    v_lshl_add_u32 v201, v201, 5, v202
    s_lshr_b32 s50, s24, 2
    s_mul_i32 s50, s50, 80
    v_bfe_u32 v10, v1, 2, 2
    v_lshl_add_u32 v10, v10, 2, s50
    ds_read_b32 v180, v10 offset:19328
    ds_read_b32 v181, v10 offset:19344
    ds_read_b32 v182, v10 offset:19360
    ds_read_b32 v183, v10 offset:19376
    ds_read_b32 v184, v10 offset:19392
    v_and_b32 v12, 3, v1
    v_lshrrev_b32 v13, 4, v1
    v_mul_u32_u24 v15, 272, v12
    v_lshl_add_u32 v15, v13, 4, v15
    s_waitcnt lgkmcnt(0)
    v_add_u32 v180, v180, v15
    v_add_u32 v181, v181, v15
    v_add_u32 v182, v182, v15
    v_add_u32 v183, v183, v15
    v_add_u32 v184, v184, v15
    s_waitcnt vmcnt(8)
    s_barrier
    ds_read_b64 v[18:19], v200 offset:19584
    ds_read_b64 v[20:21], v201
    ds_read_b32 v200, v5 offset:4
    ds_read_b32 v201, v6 offset:4
    v_add_u32 v5, 128, v5
    v_add_u32 v6, 128, v6
    s_waitcnt lgkmcnt(2)
    v_cndmask_b32 v18, 0, v18, s[62:63]
    v_cndmask_b32 v19, 0, v19, s[62:63]
    v_cndmask_b32 v20, 0, v20, s[64:65]
    v_cndmask_b32 v21, 0, v21, s[64:65]
    s_nop 1
    v_mfma_f32_4x4x4_16b_bf16 v[52:55], v[18:19], v[84:85], 0
    v_mfma_f32_4x4x4_16b_bf16 v[56:59], v[18:19], v[86:87], 0
    v_mfma_f32_4x4x4_16b_bf16 v[60:63], v[18:19], v[88:89], 0
    v_mfma_f32_4x4x4_16b_bf16 v[64:67], v[18:19], v[90:91], 0
    v_mfma_f32_4x4x4_16b_bf16 v[92:95], v[20:21], v[68:69], 0 cbsz:4 abid:0
    v_mfma_f32_4x4x4_16b_bf16 v[96:99], v[20:21], v[76:77], 0 cbsz:4 abid:0
    v_mfma_f32_4x4x4_16b_bf16 v[100:103], v[20:21], v[68:69], 0 cbsz:4 abid:4
    v_mfma_f32_4x4x4_16b_bf16 v[104:107], v[20:21], v[76:77], 0 cbsz:4 abid:4
    v_mfma_f32_4x4x4_16b_bf16 v[108:111], v[20:21], v[68:69], 0 cbsz:4 abid:8
    v_mfma_f32_4x4x4_16b_bf16 v[112:115], v[20:21], v[76:77], 0 cbsz:4 abid:8
    v_mfma_f32_4x4x4_16b_bf16 v[92:95], v[20:21], v[70:71], v[92:95] cbsz:4 abid:1
    v_mfma_f32_4x4x4_16b_bf16 v[96:99], v[20:21], v[78:79], v[96:99] cbsz:4 abid:1
    v_mfma_f32_4x4x4_16b_bf16 v[100:103], v[20:21], v[70:71], v[100:103] cbsz:4 abid:5
    v_mfma_f32_4x4x4_16b_bf16 v[104:107], v[20:21], v[78:79], v[104:107] cbsz:4 abid:5
    v_mfma_f32_4x4x4_16b_bf16 v[108:111], v[20:21], v[70:71], v[108:111] cbsz:4 abid:9
    v_mfma_f32_4x4x4_16b_bf16 v[112:115], v[20:21], v[78:79], v[112:115] cbsz:4 abid:9
    v_mfma_f32_4x4x4_16b_bf16 v[92:95], v[20:21], v[72:73], v[92:95] cbsz:4 abid:2
    v_mfma_f32_4x4x4_16b_bf16 v[96:99], v[20:21], v[80:81], v[96:99] cbsz:4 abid:2
    v_mfma_f32_4x4x4_16b_bf16 v[100:103], v[20:21], v[72:73], v[100:103] cbsz:4 abid:6
    v_mfma_f32_4x4x4_16b_bf16 v[104:107], v[20:21], v[80:81], v[104:107] cbsz:4 abid:6
    v_mfma_f32_4x4x4_16b_bf16 v[108:111], v[20:21], v[72:73], v[108:111] cbsz:4 abid:10
    v_mfma_f32_4x4x4_16b_bf16 v[112:115], v[20:21], v[80:81], v[112:115] cbsz:4 abid:10
    v_mfma_f32_4x4x4_16b_bf16 v[92:95], v[20:21], v[74:75], v[92:95] cbsz:4 abid:3
    v_mfma_f32_4x4x4_16b_bf16 v[96:99], v[20:21], v[82:83], v[96:99] cbsz:4 abid:3
    v_mfma_f32_4x4x4_16b_bf16 v[100:103], v[20:21], v[74:75], v[100:103] cbsz:4 abid:7
    v_mfma_f32_4x4x4_16b_bf16 v[104:107], v[20:21], v[82:83], v[104:107] cbsz:4 abid:7
    v_mfma_f32_4x4x4_16b_bf16 v[108:111], v[20:21], v[74:75], v[108:111] cbsz:4 abid:11
    v_mfma_f32_4x4x4_16b_bf16 v[112:115], v[20:21], v[82:83], v[112:115] cbsz:4 abid:11
    v_cvt_pk_bf16_f32 v24, v52, v56
    v_cvt_pk_bf16_f32 v25, v60, v64
    s_waitcnt lgkmcnt(0)
    v_lshlrev_b32 v200, 3, v200
    v_lshl_add_u32 v201, v201, 5, v202
    s_waitcnt vmcnt(7)
    ds_read_b64_tr_b16 v[28:29], v3 offset:0
    ds_read_b64_tr_b16 v[30:31], v3 offset:512
    s_waitcnt vmcnt(6)
    ds_read_b64_tr_b16 v[32:33], v3 offset:1024
    ds_read_b64_tr_b16 v[34:35], v3 offset:1536
    s_waitcnt lgkmcnt(2)
    v_mfma_f32_4x4x4_16b_bf16 v[36:39], v[24:25], v[28:29], 0 cbsz:4 abid:0
    v_mfma_f32_4x4x4_16b_bf16 v[40:43], v[24:25], v[30:31], 0 cbsz:4 abid:0
    s_sub_u32 s29, s28, 16
K2_loop:
    ds_read_b32 v17, v4 offset:0
    v_add_u32 v4, 128, v4
    ds_read_b64 v[18:19], v200 offset:19584
    ds_read_b64 v[22:23], v201
    v_cmp_gt_i32 s[60:61], s29, v9
    v_cmp_gt_i32 s[62:63], s29, v7
    v_cmp_gt_i32 s[64:65], s29, v8
    v_readlane_b32 s40, v16, 8
    s_add_u32 m0, s25, 0
    s_and_b32 s48, s40, s66
    buffer_load_dwordx4 v2, s[8:11], s48 offen lds
    s_waitcnt vmcnt(6)
    ds_read_b64_tr_b16 v[28:29], v3 offset:2048
    ds_read_b64_tr_b16 v[30:31], v3 offset:2560
    s_waitcnt lgkmcnt(5)
    v_mfma_f32_4x4x4_16b_bf16 v[44:47], v[24:25], v[32:33], 0 cbsz:4 abid:1
    v_mfma_f32_4x4x4_16b_bf16 v[48:51], v[24:25], v[34:35], 0 cbsz:4 abid:1
    v_mfma_f32_4x4x4_16b_bf16 v[116:119], v[20:21], v[68:69], 0 cbsz:4 abid:12
    v_mfma_f32_4x4x4_16b_bf16 v[120:123], v[20:21], v[76:77], 0 cbsz:4 abid:12
    s_set_gpr_idx_on s32, gpr_idx(DST)
    v_fmac_f32 v124, v36, v92
    v_fmac_f32 v125, v37, v92
    v_fmac_f32 v126, v38, v92
    v_fmac_f32 v127, v39, v92
    v_fmac_f32 v128, v40, v96
    v_fmac_f32 v129, v41, v96
    v_fmac_f32 v130, v42, v96
    v_fmac_f32 v131, v43, v96
    s_set_gpr_idx_off
    v_readlane_b32 s41, v16, 9
    s_add_u32 m0, s25, 1024
    s_and_b32 s49, s41, s66
    buffer_load_dwordx4 v2, s[8:11], s49 offen lds
    s_waitcnt vmcnt(6)
    ds_read_b64_tr_b16 v[32:33], v3 offset:3072
    ds_read_b64_tr_b16 v[34:35], v3 offset:3584
    s_waitcnt lgkmcnt(2)
    v_mfma_f32_4x4x4_16b_bf16 v[36:39], v[24:25], v[28:29], 0 cbsz:4 abid:2
    v_mfma_f32_4x4x4_16b_bf16 v[40:43], v[24:25], v[30:31], 0 cbsz:4 abid:2
    v_mfma_f32_4x4x4_16b_bf16 v[116:119], v[20:21], v[70:71], v[116:119] cbsz:4 abid:13
    v_mfma_f32_4x4x4_16b_bf16 v[120:123], v[20:21], v[78:79], v[120:123] cbsz:4 abid:13
    s_set_gpr_idx_on s33, gpr_idx(DST)
    v_fmac_f32 v124, v44, v93
    v_fmac_f32 v125, v45, v93
    v_fmac_f32 v126, v46, v93
    v_fmac_f32 v127, v47, v93
    v_fmac_f32 v128, v48, v97
    v_fmac_f32 v129, v49, v97
    v_fmac_f32 v130, v50, v97
    v_fmac_f32 v131, v51, v97
    s_set_gpr_idx_off
    s_waitcnt lgkmcnt(6)
    v_cndmask_b32 v17, v14, v17, s[60:61]
    s_waitcnt lgkmcnt(4)
    v_cndmask_b32 v18, 0, v18, s[62:63]
    v_cndmask_b32 v19, 0, v19, s[62:63]
    v_cndmask_b32 v22, 0, v22, s[64:65]
    v_cndmask_b32 v23, 0, v23, s[64:65]
    v_readlane_b32 s42, v16, 10
    s_add_u32 m0, s25, 2048
    s_and_b32 s48, s42, s66
    buffer_load_dwordx4 v2, s[8:11], s48 offen lds
    s_waitcnt vmcnt(6)
    ds_read_b64_tr_b16 v[28:29], v3 offset:4096
    ds_read_b64_tr_b16 v[30:31], v3 offset:4608
    s_waitcnt lgkmcnt(2)
    v_mfma_f32_4x4x4_16b_bf16 v[44:47], v[24:25], v[32:33], 0 cbsz:4 abid:3
    v_mfma_f32_4x4x4_16b_bf16 v[48:51], v[24:25], v[34:35], 0 cbsz:4 abid:3
    v_mfma_f32_4x4x4_16b_bf16 v[116:119], v[20:21], v[72:73], v[116:119] cbsz:4 abid:14
    v_mfma_f32_4x4x4_16b_bf16 v[120:123], v[20:21], v[80:81], v[120:123] cbsz:4 abid:14
    s_set_gpr_idx_on s34, gpr_idx(DST)
    v_fmac_f32 v124, v36, v94
    v_fmac_f32 v125, v37, v94
    v_fmac_f32 v126, v38, v94
    v_fmac_f32 v127, v39, v94
    v_fmac_f32 v128, v40, v98
    v_fmac_f32 v129, v41, v98
    v_fmac_f32 v130, v42, v98
    v_fmac_f32 v131, v43, v98
    s_set_gpr_idx_off
    v_readlane_b32 s43, v16, 11
    s_add_u32 m0, s25, 3072
    s_and_b32 s49, s43, s66
    buffer_load_dwordx4 v2, s[8:11], s49 offen lds
    s_waitcnt vmcnt(6)
    ds_read_b64_tr_b16 v[32:33], v3 offset:5120
    ds_read_b64_tr_b16 v[34:35], v3 offset:5632
    s_waitcnt lgkmcnt(2)
    v_mfma_f32_4x4x4_16b_bf16 v[36:39], v[24:25], v[28:29], 0 cbsz:4 abid:4
    v_mfma_f32_4x4x4_16b_bf16 v[40:43], v[24:25], v[30:31], 0 cbsz:4 abid:4
    v_mfma_f32_4x4x4_16b_bf16 v[116:119], v[20:21], v[74:75], v[116:119] cbsz:4 abid:15
    v_mfma_f32_4x4x4_16b_bf16 v[120:123], v[20:21], v[82:83], v[120:123] cbsz:4 abid:15
    s_set_gpr_idx_on s35, gpr_idx(DST)
    v_fmac_f32 v124, v44, v95
    v_fmac_f32 v125, v45, v95
    v_fmac_f32 v126, v46, v95
    v_fmac_f32 v127, v47, v95
    v_fmac_f32 v128, v48, v99
    v_fmac_f32 v129, v49, v99
    v_fmac_f32 v130, v50, v99
    v_fmac_f32 v131, v51, v99
    s_set_gpr_idx_off
    s_cmp_le_i32 s28, 4
    s_cbranch_scc1 K2_loopdone
    v_readlane_b32 s44, v16, 12
    s_add_u32 m0, s25, 4096
    s_and_b32 s48, s44, s66
    buffer_load_dwordx4 v2, s[8:11], s48 offen lds
    s_waitcnt vmcnt(6)
    ds_read_b64_tr_b16 v[28:29], v3 offset:6144
    ds_read_b64_tr_b16 v[30:31], v3 offset:6656
    s_waitcnt lgkmcnt(2)
    v_mfma_f32_4x4x4_16b_bf16 v[44:47], v[24:25], v[32:33], 0 cbsz:4 abid:5
    v_mfma_f32_4x4x4_16b_bf16 v[48:51], v[24:25], v[34:35], 0 cbsz:4 abid:5
    v_mfma_f32_4x4x4_16b_bf16 v[92:95], v[22:23], v[68:69], 0 cbsz:4 abid:0
    v_mfma_f32_4x4x4_16b_bf16 v[96:99], v[22:23], v[76:77], 0 cbsz:4 abid:0
    s_set_gpr_idx_on s36, gpr_idx(DST)
    v_fmac_f32 v124, v36, v100
    v_fmac_f32 v125, v37, v100
    v_fmac_f32 v126, v38, v100
    v_fmac_f32 v127, v39, v100
    v_fmac_f32 v128, v40, v104
    v_fmac_f32 v129, v41, v104
    v_fmac_f32 v130, v42, v104
    v_fmac_f32 v131, v43, v104
    s_set_gpr_idx_off
    v_readlane_b32 s45, v16, 13
    s_add_u32 m0, s25, 5120
    s_and_b32 s49, s45, s66
    buffer_load_dwordx4 v2, s[8:11], s49 offen lds
    s_waitcnt vmcnt(6)
    ds_read_b64_tr_b16 v[32:33], v3 offset:7168
    ds_read_b64_tr_b16 v[34:35], v3 offset:7680
    s_waitcnt lgkmcnt(2)
    v_mfma_f32_4x4x4_16b_bf16 v[36:39], v[24:25], v[28:29], 0 cbsz:4 abid:6
    v_mfma_f32_4x4x4_16b_bf16 v[40:43], v[24:25], v[30:31], 0 cbsz:4 abid:6
    v_mfma_f32_4x4x4_16b_bf16 v[92:95], v[22:23], v[70:71], v[92:95] cbsz:4 abid:1
    v_mfma_f32_4x4x4_16b_bf16 v[96:99], v[22:23], v[78:79], v[96:99] cbsz:4 abid:1
    v_mfma_f32_4x4x4_16b_bf16 v[52:55], v[18:19], v[84:85], 0
    v_mfma_f32_4x4x4_16b_bf16 v[56:59], v[18:19], v[86:87], 0
    v_mfma_f32_4x4x4_16b_bf16 v[60:63], v[18:19], v[88:89], 0
    v_mfma_f32_4x4x4_16b_bf16 v[64:67], v[18:19], v[90:91], 0
    s_set_gpr_idx_on s37, gpr_idx(DST)
    v_fmac_f32 v124, v44, v101
    v_fmac_f32 v125, v45, v101
    v_fmac_f32 v126, v46, v101
    v_fmac_f32 v127, v47, v101
    v_fmac_f32 v128, v48, v105
    v_fmac_f32 v129, v49, v105
    v_fmac_f32 v130, v50, v105
    v_fmac_f32 v131, v51, v105
    s_set_gpr_idx_off
    v_readlane_b32 s46, v16, 14
    s_add_u32 m0, s25, 6144
    s_and_b32 s48, s46, s66
    buffer_load_dwordx4 v2, s[8:11], s48 offen lds
    s_waitcnt vmcnt(6)
    ds_read_b64_tr_b16 v[28:29], v3 offset:0
    ds_read_b64_tr_b16 v[30:31], v3 offset:512
    s_waitcnt lgkmcnt(2)
    v_mfma_f32_4x4x4_16b_bf16 v[44:47], v[24:25], v[32:33], 0 cbsz:4 abid:7
    v_mfma_f32_4x4x4_16b_bf16 v[48:51], v[24:25], v[34:35], 0 cbsz:4 abid:7
    v_mfma_f32_4x4x4_16b_bf16 v[92:95], v[22:23], v[72:73], v[92:95] cbsz:4 abid:2
    v_mfma_f32_4x4x4_16b_bf16 v[96:99], v[22:23], v[80:81], v[96:99] cbsz:4 abid:2
    s_set_gpr_idx_on s38, gpr_idx(DST)
    v_fmac_f32 v124, v36, v102
    v_fmac_f32 v125, v37, v102
    v_fmac_f32 v126, v38, v102
    v_fmac_f32 v127, v39, v102
    v_fmac_f32 v128, v40, v106
    v_fmac_f32 v129, v41, v106
    v_fmac_f32 v130, v42, v106
    v_fmac_f32 v131, v43, v106
    s_set_gpr_idx_off
    v_readlane_b32 s47, v16, 15
    s_add_u32 m0, s25, 7168
    s_and_b32 s49, s47, s66
    buffer_load_dwordx4 v2, s[8:11], s49 offen lds
    s_waitcnt vmcnt(6)
    ds_read_b64_tr_b16 v[32:33], v3 offset:1024
    ds_read_b64_tr_b16 v[34:35], v3 offset:1536
    s_waitcnt lgkmcnt(2)
    v_mfma_f32_4x4x4_16b_bf16 v[36:39], v[24:25], v[28:29], 0 cbsz:4 abid:8
    v_mfma_f32_4x4x4_16b_bf16 v[40:43], v[24:25], v[30:31], 0 cbsz:4 abid:8
    v_mfma_f32_4x4x4_16b_bf16 v[92:95], v[22:23], v[74:75], v[92:95] cbsz:4 abid:3
    v_mfma_f32_4x4x4_16b_bf16 v[96:99], v[22:23], v[82:83], v[96:99] cbsz:4 abid:3
    s_set_gpr_idx_on s39, gpr_idx(DST)
    v_fmac_f32 v124, v44, v103
    v_fmac_f32 v125, v45, v103
    v_fmac_f32 v126, v46, v103
    v_fmac_f32 v127, v47, v103
    v_fmac_f32 v128, v48, v107
    v_fmac_f32 v129, v49, v107
    v_fmac_f32 v130, v50, v107
    v_fmac_f32 v131, v51, v107
    s_set_gpr_idx_off
    s_cmp_le_i32 s28, 8
    s_cbranch_scc1 K2_loopdone
    v_readlane_b32 s32, v17, 0
    s_add_u32 m0, s25, 0
    s_and_b32 s48, s32, s66
    buffer_load_dwordx4 v2, s[8:11], s48 offen lds
    s_waitcnt vmcnt(6)
    ds_read_b64_tr_b16 v[28:29], v3 offset:2048
    ds_read_b64_tr_b16 v[30:31], v3 offset:2560
    s_waitcnt lgkmcnt(2)
    v_mfma_f32_4x4x4_16b_bf16 v[44:47], v[24:25], v[32:33], 0 cbsz:4 abid:9
    v_mfma_f32_4x4x4_16b_bf16 v[48:51], v[24:25], v[34:35], 0 cbsz:4 abid:9
    v_mfma_f32_4x4x4_16b_bf16 v[100:103], v[22:23], v[68:69], 0 cbsz:4 abid:4
    v_mfma_f32_4x4x4_16b_bf16 v[104:107], v[22:23], v[76:77], 0 cbsz:4 abid:4
    v_cvt_pk_bf16_f32 v26, v52, v56
    v_cvt_pk_bf16_f32 v27, v60, v64
    s_set_gpr_idx_on s40, gpr_idx(DST)
    v_fmac_f32 v124, v36, v108
    v_fmac_f32 v125, v37, v108
    v_fmac_f32 v126, v38, v108
    v_fmac_f32 v127, v39, v108
    v_fmac_f32 v128, v40, v112
    v_fmac_f32 v129, v41, v112
    v_fmac_f32 v130, v42, v112
    v_fmac_f32 v131, v43, v112
    s_set_gpr_idx_off
    v_readlane_b32 s33, v17, 1
    s_add_u32 m0, s25, 1024
    s_and_b32 s49, s33, s66
    buffer_load_dwordx4 v2, s[8:11], s49 offen lds
    s_waitcnt vmcnt(6)
    ds_read_b64_tr_b16 v[32:33], v3 offset:3072
    ds_read_b64_tr_b16 v[34:35], v3 offset:3584
    s_waitcnt lgkmcnt(2)
    v_mfma_f32_4x4x4_16b_bf16 v[36:39], v[24:25], v[28:29], 0 cbsz:4 abid:10
    v_mfma_f32_4x4x4_16b_bf16 v[40:43], v[24:25], v[30:31], 0 cbsz:4 abid:10
    v_mfma_f32_4x4x4_16b_bf16 v[100:103], v[22:23], v[70:71], v[100:103] cbsz:4 abid:5
    v_mfma_f32_4x4x4_16b_bf16 v[104:107], v[22:23], v[78:79], v[104:107] cbsz:4 abid:5
    ds_read_b32 v200, v5 offset:4
    ds_read_b32 v201, v6 offset:4
    v_add_u32 v5, 128, v5
    v_add_u32 v6, 128, v6
    s_set_gpr_idx_on s41, gpr_idx(DST)
    v_fmac_f32 v124, v44, v109
    v_fmac_f32 v125, v45, v109
    v_fmac_f32 v126, v46, v109
    v_fmac_f32 v127, v47, v109
    v_fmac_f32 v128, v48, v113
    v_fmac_f32 v129, v49, v113
    v_fmac_f32 v130, v50, v113
    v_fmac_f32 v131, v51, v113
    s_set_gpr_idx_off
    v_readlane_b32 s34, v17, 2
    s_add_u32 m0, s25, 2048
    s_and_b32 s48, s34, s66
    buffer_load_dwordx4 v2, s[8:11], s48 offen lds
    s_waitcnt vmcnt(6)
    ds_read_b64_tr_b16 v[28:29], v3 offset:4096
    ds_read_b64_tr_b16 v[30:31], v3 offset:4608
    s_waitcnt lgkmcnt(4)
    v_mfma_f32_4x4x4_16b_bf16 v[44:47], v[24:25], v[32:33], 0 cbsz:4 abid:11
    v_mfma_f32_4x4x4_16b_bf16 v[48:51], v[24:25], v[34:35], 0 cbsz:4 abid:11
    v_mfma_f32_4x4x4_16b_bf16 v[100:103], v[22:23], v[72:73], v[100:103] cbsz:4 abid:6
    v_mfma_f32_4x4x4_16b_bf16 v[104:107], v[22:23], v[80:81], v[104:107] cbsz:4 abid:6
    s_set_gpr_idx_on s42, gpr_idx(DST)
    v_fmac_f32 v124, v36, v110
    v_fmac_f32 v125, v37, v110
    v_fmac_f32 v126, v38, v110
    v_fmac_f32 v127, v39, v110
    v_fmac_f32 v128, v40, v114
    v_fmac_f32 v129, v41, v114
    v_fmac_f32 v130, v42, v114
    v_fmac_f32 v131, v43, v114
    s_set_gpr_idx_off
    v_readlane_b32 s35, v17, 3
    s_add_u32 m0, s25, 3072
    s_and_b32 s49, s35, s66
    buffer_load_dwordx4 v2, s[8:11], s49 offen lds
    s_waitcnt vmcnt(6)
    ds_read_b64_tr_b16 v[32:33], v3 offset:5120
    ds_read_b64_tr_b16 v[34:35], v3 offset:5632
    s_waitcnt lgkmcnt(2)
    v_mfma_f32_4x4x4_16b_bf16 v[36:39], v[24:25], v[28:29], 0 cbsz:4 abid:12
    v_mfma_f32_4x4x4_16b_bf16 v[40:43], v[24:25], v[30:31], 0 cbsz:4 abid:12
    v_mfma_f32_4x4x4_16b_bf16 v[100:103], v[22:23], v[74:75], v[100:103] cbsz:4 abid:7
    v_mfma_f32_4x4x4_16b_bf16 v[104:107], v[22:23], v[82:83], v[104:107] cbsz:4 abid:7
    s_set_gpr_idx_on s43, gpr_idx(DST)
    v_fmac_f32 v124, v44, v111
    v_fmac_f32 v125, v45, v111
    v_fmac_f32 v126, v46, v111
    v_fmac_f32 v127, v47, v111
    v_fmac_f32 v128, v48, v115
    v_fmac_f32 v129, v49, v115
    v_fmac_f32 v130, v50, v115
    v_fmac_f32 v131, v51, v115
    s_set_gpr_idx_off
    s_cmp_le_i32 s28, 12
    s_cbranch_scc1 K2_loopdone
    v_readlane_b32 s36, v17, 4
    s_add_u32 m0, s25, 4096
    s_and_b32 s48, s36, s66
    buffer_load_dwordx4 v2, s[8:11], s48 offen lds
    s_waitcnt vmcnt(6)
    ds_read_b64_tr_b16 v[28:29], v3 offset:6144
    ds_read_b64_tr_b16 v[30:31], v3 offset:6656
    s_waitcnt lgkmcnt(2)
    v_mfma_f32_4x4x4_16b_bf16 v[44:47], v[24:25], v[32:33], 0 cbsz:4 abid:13
    v_mfma_f32_4x4x4_16b_bf16 v[48:51], v[24:25], v[34:35], 0 cbsz:4 abid:13
    v_mfma_f32_4x4x4_16b_bf16 v[108:111], v[22:23], v[68:69], 0 cbsz:4 abid:8
    v_mfma_f32_4x4x4_16b_bf16 v[112:115], v[22:23], v[76:77], 0 cbsz:4 abid:8
    s_waitcnt lgkmcnt(6)
    v_lshlrev_b32 v200, 3, v200
    v_lshl_add_u32 v201, v201, 5, v202
    s_set_gpr_idx_on s44, gpr_idx(DST)
    v_fmac_f32 v124, v36, v116
    v_fmac_f32 v125, v37, v116
    v_fmac_f32 v126, v38, v116
    v_fmac_f32 v127, v39, v116
    v_fmac_f32 v128, v40, v120
    v_fmac_f32 v129, v41, v120
    v_fmac_f32 v130, v42, v120
    v_fmac_f32 v131, v43, v120
    s_set_gpr_idx_off
    v_readlane_b32 s37, v17, 5
    s_add_u32 m0, s25, 5120
    s_and_b32 s49, s37, s66
    buffer_load_dwordx4 v2, s[8:11], s49 offen lds
    s_waitcnt vmcnt(6)
    ds_read_b64_tr_b16 v[32:33], v3 offset:7168
    ds_read_b64_tr_b16 v[34:35], v3 offset:7680
    s_waitcnt lgkmcnt(2)
    v_mfma_f32_4x4x4_16b_bf16 v[36:39], v[24:25], v[28:29], 0 cbsz:4 abid:14
    v_mfma_f32_4x4x4_16b_bf16 v[40:43], v[24:25], v[30:31], 0 cbsz:4 abid:14
    v_mfma_f32_4x4x4_16b_bf16 v[108:111], v[22:23], v[70:71], v[108:111] cbsz:4 abid:9
    v_mfma_f32_4x4x4_16b_bf16 v[112:115], v[22:23], v[78:79], v[112:115] cbsz:4 abid:9
    s_set_gpr_idx_on s45, gpr_idx(DST)
    v_fmac_f32 v124, v44, v117
    v_fmac_f32 v125, v45, v117
    v_fmac_f32 v126, v46, v117
    v_fmac_f32 v127, v47, v117
    v_fmac_f32 v128, v48, v121
    v_fmac_f32 v129, v49, v121
    v_fmac_f32 v130, v50, v121
    v_fmac_f32 v131, v51, v121
    s_set_gpr_idx_off
    v_readlane_b32 s38, v17, 6
    s_add_u32 m0, s25, 6144
    s_and_b32 s48, s38, s66
    buffer_load_dwordx4 v2, s[8:11], s48 offen lds
    s_waitcnt vmcnt(6)
    ds_read_b64_tr_b16 v[28:29], v3 offset:0
    ds_read_b64_tr_b16 v[30:31], v3 offset:512
    s_waitcnt lgkmcnt(2)
    v_mfma_f32_4x4x4_16b_bf16 v[44:47], v[24:25], v[32:33], 0 cbsz:4 abid:15
    v_mfma_f32_4x4x4_16b_bf16 v[48:51], v[24:25], v[34:35], 0 cbsz:4 abid:15
    v_mfma_f32_4x4x4_16b_bf16 v[108:111], v[22:23], v[72:73], v[108:111] cbsz:4 abid:10
    v_mfma_f32_4x4x4_16b_bf16 v[112:115], v[22:23], v[80:81], v[112:115] cbsz:4 abid:10
    s_set_gpr_idx_on s46, gpr_idx(DST)
    v_fmac_f32 v124, v36, v118
    v_fmac_f32 v125, v37, v118
    v_fmac_f32 v126, v38, v118
    v_fmac_f32 v127, v39, v118
    v_fmac_f32 v128, v40, v122
    v_fmac_f32 v129, v41, v122
    v_fmac_f32 v130, v42, v122
    v_fmac_f32 v131, v43, v122
    s_set_gpr_idx_off
    v_readlane_b32 s39, v17, 7
    s_add_u32 m0, s25, 7168
    s_and_b32 s49, s39, s66
    buffer_load_dwordx4 v2, s[8:11], s49 offen lds
    s_waitcnt vmcnt(6)
    ds_read_b64_tr_b16 v[32:33], v3 offset:1024
    ds_read_b64_tr_b16 v[34:35], v3 offset:1536
    s_waitcnt lgkmcnt(2)
    v_mfma_f32_4x4x4_16b_bf16 v[36:39], v[26:27], v[28:29], 0 cbsz:4 abid:0
    v_mfma_f32_4x4x4_16b_bf16 v[40:43], v[26:27], v[30:31], 0 cbsz:4 abid:0
    v_mfma_f32_4x4x4_16b_bf16 v[108:111], v[22:23], v[74:75], v[108:111] cbsz:4 abid:11
    v_mfma_f32_4x4x4_16b_bf16 v[112:115], v[22:23], v[82:83], v[112:115] cbsz:4 abid:11
    s_set_gpr_idx_on s47, gpr_idx(DST)
    v_fmac_f32 v124, v44, v119
    v_fmac_f32 v125, v45, v119
    v_fmac_f32 v126, v46, v119
    v_fmac_f32 v127, v47, v119
    v_fmac_f32 v128, v48, v123
    v_fmac_f32 v129, v49, v123
    v_fmac_f32 v130, v50, v123
    v_fmac_f32 v131, v51, v123
    s_set_gpr_idx_off
    s_cmp_le_i32 s28, 16
    s_cbranch_scc1 K2_loopdone
    s_mov_b32 s28, s29
    s_sub_u32 s29, s29, 16
    ds_read_b32 v16, v4 offset:0
    v_add_u32 v4, 128, v4
    ds_read_b64 v[18:19], v200 offset:19584
    ds_read_b64 v[20:21], v201
    v_cmp_gt_i32 s[60:61], s29, v9
    v_cmp_gt_i32 s[62:63], s29, v7
    v_cmp_gt_i32 s[64:65], s29, v8
    v_readlane_b32 s40, v17, 8
    s_add_u32 m0, s25, 0
    s_and_b32 s48, s40, s66
    buffer_load_dwordx4 v2, s[8:11], s48 offen lds
    s_waitcnt vmcnt(6)
    ds_read_b64_tr_b16 v[28:29], v3 offset:2048
    ds_read_b64_tr_b16 v[30:31], v3 offset:2560
    s_waitcnt lgkmcnt(5)
    v_mfma_f32_4x4x4_16b_bf16 v[44:47], v[26:27], v[32:33], 0 cbsz:4 abid:1
    v_mfma_f32_4x4x4_16b_bf16 v[48:51], v[26:27], v[34:35], 0 cbsz:4 abid:1
    v_mfma_f32_4x4x4_16b_bf16 v[116:119], v[22:23], v[68:69], 0 cbsz:4 abid:12
    v_mfma_f32_4x4x4_16b_bf16 v[120:123], v[22:23], v[76:77], 0 cbsz:4 abid:12
    s_set_gpr_idx_on s32, gpr_idx(DST)
    v_fmac_f32 v124, v36, v92
    v_fmac_f32 v125, v37, v92
    v_fmac_f32 v126, v38, v92
    v_fmac_f32 v127, v39, v92
    v_fmac_f32 v128, v40, v96
    v_fmac_f32 v129, v41, v96
    v_fmac_f32 v130, v42, v96
    v_fmac_f32 v131, v43, v96
    s_set_gpr_idx_off
    s_cmp_lg_u32 s82, 0
    s_cbranch_scc1 K2_wlskip
    v_lshlrev_b32 v204, 4, v1
    s_and_b32 s51, s24, 3
    s_lshl_b32 s51, s51, 13
    s_add_u32 s51, s51, 262144
    buffer_load_dwordx4 v[164:167], v204, s[96:99], s51 offen offset:0
    buffer_load_dwordx4 v[168:171], v204, s[96:99], s51 offen offset:1024
    buffer_load_dwordx4 v[172:175], v204, s[96:99], s51 offen offset:2048
    buffer_load_dwordx4 v[176:179], v204, s[96:99], s51 offen offset:3072
    s_add_u32 s51, s51, 4096
    buffer_load_dwordx4 v[208:211], v204, s[96:99], s51 offen offset:0
    buffer_load_dwordx4 v[212:215], v204, s[96:99], s51 offen offset:1024
    buffer_load_dwordx4 v[216:219], v204, s[96:99], s51 offen offset:2048
    buffer_load_dwordx4 v[220:223], v204, s[96:99], s51 offen offset:3072
    s_mov_b32 s82, 1
K2_wlskip:
    v_readlane_b32 s41, v17, 9
    s_add_u32 m0, s25, 1024
    s_and_b32 s49, s41, s66
    buffer_load_dwordx4 v2, s[8:11], s49 offen lds
    s_waitcnt vmcnt(6)
    ds_read_b64_tr_b16 v[32:33], v3 offset:3072
    ds_read_b64_tr_b16 v[34:35], v3 offset:3584
    s_waitcnt lgkmcnt(2)
    v_mfma_f32_4x4x4_16b_bf16 v[36:39], v[26:27], v[28:29], 0 cbsz:4 abid:2
    v_mfma_f32_4x4x4_16b_bf16 v[40:43], v[26:27], v[30:31], 0 cbsz:4 abid:2
    v_mfma_f32_4x4x4_16b_bf16 v[116:119], v[22:23], v[70:71], v[116:119] cbsz:4 abid:13
    v_mfma_f32_4x4x4_16b_bf16 v[120:123], v[22:23], v[78:79], v[120:123] cbsz:4 abid:13
    s_set_gpr_idx_on s33, gpr_idx(DST)
    v_fmac_f32 v124, v44, v93
    v_fmac_f32 v125, v45, v93
    v_fmac_f32 v126, v46, v93
    v_fmac_f32 v127, v47, v93
    v_fmac_f32 v128, v48, v97
    v_fmac_f32 v129, v49, v97
    v_fmac_f32 v130, v50, v97
    v_fmac_f32 v131, v51, v97
    s_set_gpr_idx_off
    s_waitcnt lgkmcnt(6)
    v_cndmask_b32 v16, v14, v16, s[60:61]
    s_waitcnt lgkmcnt(4)
    v_cndmask_b32 v18, 0, v18, s[62:63]
    v_cndmask_b32 v19, 0, v19, s[62:63]
    v_cndmask_b32 v20, 0, v20, s[64:65]
    v_cndmask_b32 v21, 0, v21, s[64:65]
    v_readlane_b32 s42, v17, 10
    s_add_u32 m0, s25, 2048
    s_and_b32 s48, s42, s66
    buffer_load_dwordx4 v2, s[8:11], s48 offen lds
    s_waitcnt vmcnt(6)
    ds_read_b64_tr_b16 v[28:29], v3 offset:4096
    ds_read_b64_tr_b16 v[30:31], v3 offset:4608
    s_waitcnt lgkmcnt(2)
    v_mfma_f32_4x4x4_16b_bf16 v[44:47], v[26:27], v[32:33], 0 cbsz:4 abid:3
    v_mfma_f32_4x4x4_16b_bf16 v[48:51], v[26:27], v[34:35], 0 cbsz:4 abid:3
    v_mfma_f32_4x4x4_16b_bf16 v[116:119], v[22:23], v[72:73], v[116:119] cbsz:4 abid:14
    v_mfma_f32_4x4x4_16b_bf16 v[120:123], v[22:23], v[80:81], v[120:123] cbsz:4 abid:14
    s_set_gpr_idx_on s34, gpr_idx(DST)
    v_fmac_f32 v124, v36, v94
    v_fmac_f32 v125, v37, v94
    v_fmac_f32 v126, v38, v94
    v_fmac_f32 v127, v39, v94
    v_fmac_f32 v128, v40, v98
    v_fmac_f32 v129, v41, v98
    v_fmac_f32 v130, v42, v98
    v_fmac_f32 v131, v43, v98
    s_set_gpr_idx_off
    v_readlane_b32 s43, v17, 11
    s_add_u32 m0, s25, 3072
    s_and_b32 s49, s43, s66
    buffer_load_dwordx4 v2, s[8:11], s49 offen lds
    s_waitcnt vmcnt(6)
    ds_read_b64_tr_b16 v[32:33], v3 offset:5120
    ds_read_b64_tr_b16 v[34:35], v3 offset:5632
    s_waitcnt lgkmcnt(2)
    v_mfma_f32_4x4x4_16b_bf16 v[36:39], v[26:27], v[28:29], 0 cbsz:4 abid:4
    v_mfma_f32_4x4x4_16b_bf16 v[40:43], v[26:27], v[30:31], 0 cbsz:4 abid:4
    v_mfma_f32_4x4x4_16b_bf16 v[116:119], v[22:23], v[74:75], v[116:119] cbsz:4 abid:15
    v_mfma_f32_4x4x4_16b_bf16 v[120:123], v[22:23], v[82:83], v[120:123] cbsz:4 abid:15
    s_set_gpr_idx_on s35, gpr_idx(DST)
    v_fmac_f32 v124, v44, v95
    v_fmac_f32 v125, v45, v95
    v_fmac_f32 v126, v46, v95
    v_fmac_f32 v127, v47, v95
    v_fmac_f32 v128, v48, v99
    v_fmac_f32 v129, v49, v99
    v_fmac_f32 v130, v50, v99
    v_fmac_f32 v131, v51, v99
    s_set_gpr_idx_off
    s_cmp_le_i32 s28, 4
    s_cbranch_scc1 K2_loopdone
    v_readlane_b32 s44, v17, 12
    s_add_u32 m0, s25, 4096
    s_and_b32 s48, s44, s66
    buffer_load_dwordx4 v2, s[8:11], s48 offen lds
    s_waitcnt vmcnt(6)
    ds_read_b64_tr_b16 v[28:29], v3 offset:6144
    ds_read_b64_tr_b16 v[30:31], v3 offset:6656
    s_waitcnt lgkmcnt(2)
    v_mfma_f32_4x4x4_16b_bf16 v[44:47], v[26:27], v[32:33], 0 cbsz:4 abid:5
    v_mfma_f32_4x4x4_16b_bf16 v[48:51], v[26:27], v[34:35], 0 cbsz:4 abid:5
    v_mfma_f32_4x4x4_16b_bf16 v[92:95], v[20:21], v[68:69], 0 cbsz:4 abid:0
    v_mfma_f32_4x4x4_16b_bf16 v[96:99], v[20:21], v[76:77], 0 cbsz:4 abid:0
    s_set_gpr_idx_on s36, gpr_idx(DST)
    v_fmac_f32 v124, v36, v100
    v_fmac_f32 v125, v37, v100
    v_fmac_f32 v126, v38, v100
    v_fmac_f32 v127, v39, v100
    v_fmac_f32 v128, v40, v104
    v_fmac_f32 v129, v41, v104
    v_fmac_f32 v130, v42, v104
    v_fmac_f32 v131, v43, v104
    s_set_gpr_idx_off
    v_readlane_b32 s45, v17, 13
    s_add_u32 m0, s25, 5120
    s_and_b32 s49, s45, s66
    buffer_load_dwordx4 v2, s[8:11], s49 offen lds
    s_waitcnt vmcnt(6)
    ds_read_b64_tr_b16 v[32:33], v3 offset:7168
    ds_read_b64_tr_b16 v[34:35], v3 offset:7680
    s_waitcnt lgkmcnt(2)
    v_mfma_f32_4x4x4_16b_bf16 v[36:39], v[26:27], v[28:29], 0 cbsz:4 abid:6
    v_mfma_f32_4x4x4_16b_bf16 v[40:43], v[26:27], v[30:31], 0 cbsz:4 abid:6
    v_mfma_f32_4x4x4_16b_bf16 v[92:95], v[20:21], v[70:71], v[92:95] cbsz:4 abid:1
    v_mfma_f32_4x4x4_16b_bf16 v[96:99], v[20:21], v[78:79], v[96:99] cbsz:4 abid:1
    v_mfma_f32_4x4x4_16b_bf16 v[52:55], v[18:19], v[84:85], 0
    v_mfma_f32_4x4x4_16b_bf16 v[56:59], v[18:19], v[86:87], 0
    v_mfma_f32_4x4x4_16b_bf16 v[60:63], v[18:19], v[88:89], 0
    v_mfma_f32_4x4x4_16b_bf16 v[64:67], v[18:19], v[90:91], 0
    s_set_gpr_idx_on s37, gpr_idx(DST)
    v_fmac_f32 v124, v44, v101
    v_fmac_f32 v125, v45, v101
    v_fmac_f32 v126, v46, v101
    v_fmac_f32 v127, v47, v101
    v_fmac_f32 v128, v48, v105
    v_fmac_f32 v129, v49, v105
    v_fmac_f32 v130, v50, v105
    v_fmac_f32 v131, v51, v105
    s_set_gpr_idx_off
    v_readlane_b32 s46, v17, 14
    s_add_u32 m0, s25, 6144
    s_and_b32 s48, s46, s66
    buffer_load_dwordx4 v2, s[8:11], s48 offen lds
    s_waitcnt vmcnt(6)
    ds_read_b64_tr_b16 v[28:29], v3 offset:0
    ds_read_b64_tr_b16 v[30:31], v3 offset:512
    s_waitcnt lgkmcnt(2)
    v_mfma_f32_4x4x4_16b_bf16 v[44:47], v[26:27], v[32:33], 0 cbsz:4 abid:7
    v_mfma_f32_4x4x4_16b_bf16 v[48:51], v[26:27], v[34:35], 0 cbsz:4 abid:7
    v_mfma_f32_4x4x4_16b_bf16 v[92:95], v[20:21], v[72:73], v[92:95] cbsz:4 abid:2
    v_mfma_f32_4x4x4_16b_bf16 v[96:99], v[20:21], v[80:81], v[96:99] cbsz:4 abid:2
    s_set_gpr_idx_on s38, gpr_idx(DST)
    v_fmac_f32 v124, v36, v102
    v_fmac_f32 v125, v37, v102
    v_fmac_f32 v126, v38, v102
    v_fmac_f32 v127, v39, v102
    v_fmac_f32 v128, v40, v106
    v_fmac_f32 v129, v41, v106
    v_fmac_f32 v130, v42, v106
    v_fmac_f32 v131, v43, v106
    s_set_gpr_idx_off
    v_readlane_b32 s47, v17, 15
    s_add_u32 m0, s25, 7168
    s_and_b32 s49, s47, s66
    buffer_load_dwordx4 v2, s[8:11], s49 offen lds
    s_waitcnt vmcnt(6)
    ds_read_b64_tr_b16 v[32:33], v3 offset:1024
    ds_read_b64_tr_b16 v[34:35], v3 offset:1536
    s_waitcnt lgkmcnt(2)
    v_mfma_f32_4x4x4_16b_bf16 v[36:39], v[26:27], v[28:29], 0 cbsz:4 abid:8
    v_mfma_f32_4x4x4_16b_bf16 v[40:43], v[26:27], v[30:31], 0 cbsz:4 abid:8
    v_mfma_f32_4x4x4_16b_bf16 v[92:95], v[20:21], v[74:75], v[92:95] cbsz:4 abid:3
    v_mfma_f32_4x4x4_16b_bf16 v[96:99], v[20:21], v[82:83], v[96:99] cbsz:4 abid:3
    s_set_gpr_idx_on s39, gpr_idx(DST)
    v_fmac_f32 v124, v44, v103
    v_fmac_f32 v125, v45, v103
    v_fmac_f32 v126, v46, v103
    v_fmac_f32 v127, v47, v103
    v_fmac_f32 v128, v48, v107
    v_fmac_f32 v129, v49, v107
    v_fmac_f32 v130, v50, v107
    v_fmac_f32 v131, v51, v107
    s_set_gpr_idx_off
    s_cmp_le_i32 s28, 8
    s_cbranch_scc1 K2_loopdone
    v_readlane_b32 s32, v16, 0
    s_add_u32 m0, s25, 0
    s_and_b32 s48, s32, s66
    buffer_load_dwordx4 v2, s[8:11], s48 offen lds
    s_waitcnt vmcnt(6)
    ds_read_b64_tr_b16 v[28:29], v3 offset:2048
    ds_read_b64_tr_b16 v[30:31], v3 offset:2560
    s_waitcnt lgkmcnt(2)
    v_mfma_f32_4x4x4_16b_bf16 v[44:47], v[26:27], v[32:33], 0 cbsz:4 abid:9
    v_mfma_f32_4x4x4_16b_bf16 v[48:51], v[26:27], v[34:35], 0 cbsz:4 abid:9
    v_mfma_f32_4x4x4_16b_bf16 v[100:103], v[20:21], v[68:69], 0 cbsz:4 abid:4
    v_mfma_f32_4x4x4_16b_bf16 v[104:107], v[20:21], v[76:77], 0 cbsz:4 abid:4
    v_cvt_pk_bf16_f32 v24, v52, v56
    v_cvt_pk_bf16_f32 v25, v60, v64
    s_set_gpr_idx_on s40, gpr_idx(DST)
    v_fmac_f32 v124, v36, v108
    v_fmac_f32 v125, v37, v108
    v_fmac_f32 v126, v38, v108
    v_fmac_f32 v127, v39, v108
    v_fmac_f32 v128, v40, v112
    v_fmac_f32 v129, v41, v112
    v_fmac_f32 v130, v42, v112
    v_fmac_f32 v131, v43, v112
    s_set_gpr_idx_off
    v_readlane_b32 s33, v16, 1
    s_add_u32 m0, s25, 1024
    s_and_b32 s49, s33, s66
    buffer_load_dwordx4 v2, s[8:11], s49 offen lds
    s_waitcnt vmcnt(6)
    ds_read_b64_tr_b16 v[32:33], v3 offset:3072
    ds_read_b64_tr_b16 v[34:35], v3 offset:3584
    s_waitcnt lgkmcnt(2)
    v_mfma_f32_4x4x4_16b_bf16 v[36:39], v[26:27], v[28:29], 0 cbsz:4 abid:10
    v_mfma_f32_4x4x4_16b_bf16 v[40:43], v[26:27], v[30:31], 0 cbsz:4 abid:10
    v_mfma_f32_4x4x4_16b_bf16 v[100:103], v[20:21], v[70:71], v[100:103] cbsz:4 abid:5
    v_mfma_f32_4x4x4_16b_bf16 v[104:107], v[20:21], v[78:79], v[104:107] cbsz:4 abid:5
    ds_read_b32 v200, v5 offset:4
    ds_read_b32 v201, v6 offset:4
    v_add_u32 v5, 128, v5
    v_add_u32 v6, 128, v6
    s_set_gpr_idx_on s41, gpr_idx(DST)
    v_fmac_f32 v124, v44, v109
    v_fmac_f32 v125, v45, v109
    v_fmac_f32 v126, v46, v109
    v_fmac_f32 v127, v47, v109
    v_fmac_f32 v128, v48, v113
    v_fmac_f32 v129, v49, v113
    v_fmac_f32 v130, v50, v113
    v_fmac_f32 v131, v51, v113
    s_set_gpr_idx_off
    v_readlane_b32 s34, v16, 2
    s_add_u32 m0, s25, 2048
    s_and_b32 s48, s34, s66
    buffer_load_dwordx4 v2, s[8:11], s48 offen lds
    s_waitcnt vmcnt(6)
    ds_read_b64_tr_b16 v[28:29], v3 offset:4096
    ds_read_b64_tr_b16 v[30:31], v3 offset:4608
    s_waitcnt lgkmcnt(4)
    v_mfma_f32_4x4x4_16b_bf16 v[44:47], v[26:27], v[32:33], 0 cbsz:4 abid:11
    v_mfma_f32_4x4x4_16b_bf16 v[48:51], v[26:27], v[34:35], 0 cbsz:4 abid:11
    v_mfma_f32_4x4x4_16b_bf16 v[100:103], v[20:21], v[72:73], v[100:103] cbsz:4 abid:6
    v_mfma_f32_4x4x4_16b_bf16 v[104:107], v[20:21], v[80:81], v[104:107] cbsz:4 abid:6
    s_set_gpr_idx_on s42, gpr_idx(DST)
    v_fmac_f32 v124, v36, v110
    v_fmac_f32 v125, v37, v110
    v_fmac_f32 v126, v38, v110
    v_fmac_f32 v127, v39, v110
    v_fmac_f32 v128, v40, v114
    v_fmac_f32 v129, v41, v114
    v_fmac_f32 v130, v42, v114
    v_fmac_f32 v131, v43, v114
    s_set_gpr_idx_off
    v_readlane_b32 s35, v16, 3
    s_add_u32 m0, s25, 3072
    s_and_b32 s49, s35, s66
    buffer_load_dwordx4 v2, s[8:11], s49 offen lds
    s_waitcnt vmcnt(6)
    ds_read_b64_tr_b16 v[32:33], v3 offset:5120
    ds_read_b64_tr_b16 v[34:35], v3 offset:5632
    s_waitcnt lgkmcnt(2)
    v_mfma_f32_4x4x4_16b_bf16 v[36:39], v[26:27], v[28:29], 0 cbsz:4 abid:12
    v_mfma_f32_4x4x4_16b_bf16 v[40:43], v[26:27], v[30:31], 0 cbsz:4 abid:12
    v_mfma_f32_4x4x4_16b_bf16 v[100:103], v[20:21], v[74:75], v[100:103] cbsz:4 abid:7
    v_mfma_f32_4x4x4_16b_bf16 v[104:107], v[20:21], v[82:83], v[104:107] cbsz:4 abid:7
    s_set_gpr_idx_on s43, gpr_idx(DST)
    v_fmac_f32 v124, v44, v111
    v_fmac_f32 v125, v45, v111
    v_fmac_f32 v126, v46, v111
    v_fmac_f32 v127, v47, v111
    v_fmac_f32 v128, v48, v115
    v_fmac_f32 v129, v49, v115
    v_fmac_f32 v130, v50, v115
    v_fmac_f32 v131, v51, v115
    s_set_gpr_idx_off
    s_cmp_le_i32 s28, 12
    s_cbranch_scc1 K2_loopdone
    v_readlane_b32 s36, v16, 4
    s_add_u32 m0, s25, 4096
    s_and_b32 s48, s36, s66
    buffer_load_dwordx4 v2, s[8:11], s48 offen lds
    s_waitcnt vmcnt(6)
    ds_read_b64_tr_b16 v[28:29], v3 offset:6144
    ds_read_b64_tr_b16 v[30:31], v3 offset:6656
    s_waitcnt lgkmcnt(2)
    v_mfma_f32_4x4x4_16b_bf16 v[44:47], v[26:27], v[32:33], 0 cbsz:4 abid:13
    v_mfma_f32_4x4x4_16b_bf16 v[48:51], v[26:27], v[34:35], 0 cbsz:4 abid:13
    v_mfma_f32_4x4x4_16b_bf16 v[108:111], v[20:21], v[68:69], 0 cbsz:4 abid:8
    v_mfma_f32_4x4x4_16b_bf16 v[112:115], v[20:21], v[76:77], 0 cbsz:4 abid:8
    s_waitcnt lgkmcnt(6)
    v_lshlrev_b32 v200, 3, v200
    v_lshl_add_u32 v201, v201, 5, v202
    s_set_gpr_idx_on s44, gpr_idx(DST)
    v_fmac_f32 v124, v36, v116
    v_fmac_f32 v125, v37, v116
    v_fmac_f32 v126, v38, v116
    v_fmac_f32 v127, v39, v116
    v_fmac_f32 v128, v40, v120
    v_fmac_f32 v129, v41, v120
    v_fmac_f32 v130, v42, v120
    v_fmac_f32 v131, v43, v120
    s_set_gpr_idx_off
    v_readlane_b32 s37, v16, 5
    s_add_u32 m0, s25, 5120
    s_and_b32 s49, s37, s66
    buffer_load_dwordx4 v2, s[8:11], s49 offen lds
    s_waitcnt vmcnt(6)
    ds_read_b64_tr_b16 v[32:33], v3 offset:7168
    ds_read_b64_tr_b16 v[34:35], v3 offset:7680
    s_waitcnt lgkmcnt(2)
    v_mfma_f32_4x4x4_16b_bf16 v[36:39], v[26:27], v[28:29], 0 cbsz:4 abid:14
    v_mfma_f32_4x4x4_16b_bf16 v[40:43], v[26:27], v[30:31], 0 cbsz:4 abid:14
    v_mfma_f32_4x4x4_16b_bf16 v[108:111], v[20:21], v[70:71], v[108:111] cbsz:4 abid:9
    v_mfma_f32_4x4x4_16b_bf16 v[112:115], v[20:21], v[78:79], v[112:115] cbsz:4 abid:9
    s_set_gpr_idx_on s45, gpr_idx(DST)
    v_fmac_f32 v124, v44, v117
    v_fmac_f32 v125, v45, v117
    v_fmac_f32 v126, v46, v117
    v_fmac_f32 v127, v47, v117
    v_fmac_f32 v128, v48, v121
    v_fmac_f32 v129, v49, v121
    v_fmac_f32 v130, v50, v121
    v_fmac_f32 v131, v51, v121
    s_set_gpr_idx_off
    v_readlane_b32 s38, v16, 6
    s_add_u32 m0, s25, 6144
    s_and_b32 s48, s38, s66
    buffer_load_dwordx4 v2, s[8:11], s48 offen lds
    s_waitcnt vmcnt(6)
    ds_read_b64_tr_b16 v[28:29], v3 offset:0
    ds_read_b64_tr_b16 v[30:31], v3 offset:512
    s_waitcnt lgkmcnt(2)
    v_mfma_f32_4x4x4_16b_bf16 v[44:47], v[26:27], v[32:33], 0 cbsz:4 abid:15
    v_mfma_f32_4x4x4_16b_bf16 v[48:51], v[26:27], v[34:35], 0 cbsz:4 abid:15
    v_mfma_f32_4x4x4_16b_bf16 v[108:111], v[20:21], v[72:73], v[108:111] cbsz:4 abid:10
    v_mfma_f32_4x4x4_16b_bf16 v[112:115], v[20:21], v[80:81], v[112:115] cbsz:4 abid:10
    s_set_gpr_idx_on s46, gpr_idx(DST)
    v_fmac_f32 v124, v36, v118
    v_fmac_f32 v125, v37, v118
    v_fmac_f32 v126, v38, v118
    v_fmac_f32 v127, v39, v118
    v_fmac_f32 v128, v40, v122
    v_fmac_f32 v129, v41, v122
    v_fmac_f32 v130, v42, v122
    v_fmac_f32 v131, v43, v122
    s_set_gpr_idx_off
    v_readlane_b32 s39, v16, 7
    s_add_u32 m0, s25, 7168
    s_and_b32 s49, s39, s66
    buffer_load_dwordx4 v2, s[8:11], s49 offen lds
    s_waitcnt vmcnt(6)
    ds_read_b64_tr_b16 v[32:33], v3 offset:1024
    ds_read_b64_tr_b16 v[34:35], v3 offset:1536
    s_waitcnt lgkmcnt(2)
    v_mfma_f32_4x4x4_16b_bf16 v[36:39], v[24:25], v[28:29], 0 cbsz:4 abid:0
    v_mfma_f32_4x4x4_16b_bf16 v[40:43], v[24:25], v[30:31], 0 cbsz:4 abid:0
    v_mfma_f32_4x4x4_16b_bf16 v[108:111], v[20:21], v[74:75], v[108:111] cbsz:4 abid:11
    v_mfma_f32_4x4x4_16b_bf16 v[112:115], v[20:21], v[82:83], v[112:115] cbsz:4 abid:11
    s_set_gpr_idx_on s47, gpr_idx(DST)
    v_fmac_f32 v124, v44, v119
    v_fmac_f32 v125, v45, v119
    v_fmac_f32 v126, v46, v119
    v_fmac_f32 v127, v47, v119
    v_fmac_f32 v128, v48, v123
    v_fmac_f32 v129, v49, v123
    v_fmac_f32 v130, v50, v123
    v_fmac_f32 v131, v51, v123
    s_set_gpr_idx_off
    s_cmp_le_i32 s28, 16
    s_cbranch_scc1 K2_loopdone
    s_mov_b32 s28, s29
    s_sub_u32 s29, s29, 16
    s_branch K2_loop
K2_loopdone:
    s_cmp_lg_u32 s82, 0
    s_cbranch_scc1 K2_wldone
    v_lshlrev_b32 v204, 4, v1
    s_and_b32 s51, s24, 3
    s_lshl_b32 s51, s51, 13
    s_add_u32 s51, s51, 262144
    buffer_load_dwordx4 v[164:167], v204, s[96:99], s51 offen offset:0
    buffer_load_dwordx4 v[168:171], v204, s[96:99], s51 offen offset:1024
    buffer_load_dwordx4 v[172:175], v204, s[96:99], s51 offen offset:2048
    buffer_load_dwordx4 v[176:179], v204, s[96:99], s51 offen offset:3072
    s_add_u32 s51, s51, 4096
    buffer_load_dwordx4 v[208:211], v204, s[96:99], s51 offen offset:0
    buffer_load_dwordx4 v[212:215], v204, s[96:99], s51 offen offset:1024
    buffer_load_dwordx4 v[216:219], v204, s[96:99], s51 offen offset:2048
    buffer_load_dwordx4 v[220:223], v204, s[96:99], s51 offen offset:3072
    s_mov_b32 s82, 1
K2_wldone:
    s_waitcnt vmcnt(0) lgkmcnt(0)
    s_cmp_lg_u32 s30, 0
    s_cbranch_scc1 K2_slownext
K2_epi:
    v_lshl_add_u32 v10, v1, 2, s25
    s_and_b32 s50, s76, 3
    s_lshl_b32 s50, s50, 6
    v_add_u32 v11, s50, v10
    v_cvt_pk_bf16_f32 v36, v124, v128
    ds_write_b32 v11, v36 offset:0
    v_cvt_pk_bf16_f32 v37, v125, v129
    ds_write_b32 v11, v37 offset:272
    v_cvt_pk_bf16_f32 v38, v126, v130
    ds_write_b32 v11, v38 offset:544
    v_cvt_pk_bf16_f32 v39, v127, v131
    ds_write_b32 v11, v39 offset:816
    s_and_b32 s50, s77, 3
    s_lshl_b32 s50, s50, 6
    v_add_u32 v12, s50, v10
    v_cvt_pk_bf16_f32 v40, v132, v136
    ds_write_b32 v12, v40 offset:1280
    v_cvt_pk_bf16_f32 v41, v133, v137
    ds_write_b32 v12, v41 offset:1552
    v_cvt_pk_bf16_f32 v42, v134, v138
    ds_write_b32 v12, v42 offset:1824
    v_cvt_pk_bf16_f32 v43, v135, v139
    ds_write_b32 v12, v43 offset:2096
    s_and_b32 s50, s78, 3
    s_lshl_b32 s50, s50, 6
    v_add_u32 v11, s50, v10
    v_cvt_pk_bf16_f32 v36, v140, v144
    ds_write_b32 v11, v36 offset:2560
    v_cvt_pk_bf16_f32 v37, v141, v145
    ds_write_b32 v11, v37 offset:2832
    v_cvt_pk_bf16_f32 v38, v142, v146
    ds_write_b32 v11, v38 offset:3104
    v_cvt_pk_bf16_f32 v39, v143, v147
    ds_write_b32 v11, v39 offset:3376
    s_and_b32 s50, s79, 3
    s_lshl_b32 s50, s50, 6
    v_add_u32 v12, s50, v10
    v_cvt_pk_bf16_f32 v40, v148, v152
    ds_write_b32 v12, v40 offset:3840
    v_cvt_pk_bf16_f32 v41, v149, v153
    ds_write_b32 v12, v41 offset:4112
    v_cvt_pk_bf16_f32 v42, v150, v154
    ds_write_b32 v12, v42 offset:4384
    v_cvt_pk_bf16_f32 v43, v151, v155
    ds_write_b32 v12, v43 offset:4656
    s_and_b32 s50, s80, 3
    s_lshl_b32 s50, s50, 6
    v_add_u32 v11, s50, v10
    v_cvt_pk_bf16_f32 v36, v156, v160
    ds_write_b32 v11, v36 offset:5120
    v_cvt_pk_bf16_f32 v37, v157, v161
    ds_write_b32 v11, v37 offset:5392
    v_cvt_pk_bf16_f32 v38, v158, v162
    ds_write_b32 v11, v38 offset:5664
    v_cvt_pk_bf16_f32 v39, v159, v163
    ds_write_b32 v11, v39 offset:5936
    v_mul_u32_u24 v11, 272, v9
    v_lshrrev_b32 v12, 4, v1
    v_lshl_add_u32 v11, v12, 3, v11
    s_and_b32 s50, s24, 3
    s_lshl_b32 s50, s50, 6
    s_lshr_b32 s51, s24, 2
    s_mul_i32 s51, s51, 21760
    s_add_u32 s50, s50, s51
    s_add_u32 s50, s50, 31872
    v_add_u32 v11, s50, v11
    s_mul_i32 s51, s24, 5440
    s_add_u32 s51, s51, 31872
    v_mul_u32_u24 v13, 272, v12
    v_lshl_add_u32 v13, v9, 4, v13
    v_add_u32 v13, s51, v13
    s_mul_i32 s52, s3, 40960
    s_mul_i32 s53, s24, 5120
    s_add_u32 s52, s52, s53
    v_lshlrev_b32 v15, 4, v1
    s_waitcnt lgkmcnt(0)
    s_barrier
    ds_read_b128 v[124:127], v180 offset:0
    ds_read_b128 v[128:131], v180 offset:64
    ds_read_b128 v[132:135], v180 offset:128
    ds_read_b128 v[136:139], v180 offset:192
    ds_read_b128 v[140:143], v181 offset:0
    ds_read_b128 v[144:147], v181 offset:64
    ds_read_b128 v[148:151], v181 offset:128
    ds_read_b128 v[152:155], v181 offset:192
    s_waitcnt lgkmcnt(4)
    v_mfma_f32_16x16x32_bf16 v[36:39], v[164:167], v[124:127], 0
    v_mfma_f32_16x16x32_bf16 v[40:43], v[208:211], v[124:127], 0
    v_mfma_f32_16x16x32_bf16 v[36:39], v[168:171], v[128:131], v[36:39]
    v_mfma_f32_16x16x32_bf16 v[40:43], v[212:215], v[128:131], v[40:43]
    v_mfma_f32_16x16x32_bf16 v[36:39], v[172:175], v[132:135], v[36:39]
    v_mfma_f32_16x16x32_bf16 v[40:43], v[216:219], v[132:135], v[40:43]
    v_mfma_f32_16x16x32_bf16 v[36:39], v[176:179], v[136:139], v[36:39]
    v_mfma_f32_16x16x32_bf16 v[40:43], v[220:223], v[136:139], v[40:43]
    ds_read_b128 v[124:127], v182 offset:0
    ds_read_b128 v[128:131], v182 offset:64
    ds_read_b128 v[132:135], v182 offset:128
    ds_read_b128 v[136:139], v182 offset:192
    s_waitcnt lgkmcnt(4)
    v_mfma_f32_16x16x32_bf16 v[44:47], v[164:167], v[140:143], 0
    v_mfma_f32_16x16x32_bf16 v[48:51], v[208:211], v[140:143], 0
    v_mfma_f32_16x16x32_bf16 v[44:47], v[168:171], v[144:147], v[44:47]
    v_mfma_f32_16x16x32_bf16 v[48:51], v[212:215], v[144:147], v[48:51]
    v_mfma_f32_16x16x32_bf16 v[44:47], v[172:175], v[148:151], v[44:47]
    v_mfma_f32_16x16x32_bf16 v[48:51], v[216:219], v[148:151], v[48:51]
    v_mfma_f32_16x16x32_bf16 v[44:47], v[176:179], v[152:155], v[44:47]
    v_mfma_f32_16x16x32_bf16 v[48:51], v[220:223], v[152:155], v[48:51]
    v_cvt_pk_bf16_f32 v52, v36, v37
    v_cvt_pk_bf16_f32 v53, v38, v39
    ds_write_b64 v11, v[52:53] offset:0
    v_cvt_pk_bf16_f32 v54, v40, v41
    v_cvt_pk_bf16_f32 v55, v42, v43
    ds_write_b64 v11, v[54:55] offset:32
    ds_read_b128 v[140:143], v183 offset:0
    ds_read_b128 v[144:147], v183 offset:64
    ds_read_b128 v[148:151], v183 offset:128
    ds_read_b128 v[152:155], v183 offset:192
    s_waitcnt lgkmcnt(6)
    v_mfma_f32_16x16x32_bf16 v[36:39], v[164:167], v[124:127], 0
    v_mfma_f32_16x16x32_bf16 v[40:43], v[208:211], v[124:127], 0
    v_mfma_f32_16x16x32_bf16 v[36:39], v[168:171], v[128:131], v[36:39]
    v_mfma_f32_16x16x32_bf16 v[40:43], v[212:215], v[128:131], v[40:43]
    v_mfma_f32_16x16x32_bf16 v[36:39], v[172:175], v[132:135], v[36:39]
    v_mfma_f32_16x16x32_bf16 v[40:43], v[216:219], v[132:135], v[40:43]
    v_mfma_f32_16x16x32_bf16 v[36:39], v[176:179], v[136:139], v[36:39]
    v_mfma_f32_16x16x32_bf16 v[40:43], v[220:223], v[136:139], v[40:43]
    v_cvt_pk_bf16_f32 v56, v44, v45
    v_cvt_pk_bf16_f32 v57, v46, v47
    ds_write_b64 v11, v[56:57] offset:4352
    v_cvt_pk_bf16_f32 v58, v48, v49
    v_cvt_pk_bf16_f32 v59, v50, v51
    ds_write_b64 v11, v[58:59] offset:4384
    ds_read_b128 v[124:127], v184 offset:0
    ds_read_b128 v[128:131], v184 offset:64
    ds_read_b128 v[132:135], v184 offset:128
    ds_read_b128 v[136:139], v184 offset:192
    s_waitcnt lgkmcnt(6)
    v_mfma_f32_16x16x32_bf16 v[44:47], v[164:167], v[140:143], 0
    v_mfma_f32_16x16x32_bf16 v[48:51], v[208:211], v[140:143], 0
    v_mfma_f32_16x16x32_bf16 v[44:47], v[168:171], v[144:147], v[44:47]
    v_mfma_f32_16x16x32_bf16 v[48:51], v[212:215], v[144:147], v[48:51]
    v_mfma_f32_16x16x32_bf16 v[44:47], v[172:175], v[148:151], v[44:47]
    v_mfma_f32_16x16x32_bf16 v[48:51], v[216:219], v[148:151], v[48:51]
    v_mfma_f32_16x16x32_bf16 v[44:47], v[176:179], v[152:155], v[44:47]
    v_mfma_f32_16x16x32_bf16 v[48:51], v[220:223], v[152:155], v[48:51]
    v_cvt_pk_bf16_f32 v52, v36, v37
    v_cvt_pk_bf16_f32 v53, v38, v39
    ds_write_b64 v11, v[52:53] offset:8704
    v_cvt_pk_bf16_f32 v54, v40, v41
    v_cvt_pk_bf16_f32 v55, v42, v43
    ds_write_b64 v11, v[54:55] offset:8736
    s_waitcnt lgkmcnt(2)
    v_mfma_f32_16x16x32_bf16 v[36:39], v[164:167], v[124:127], 0
    v_mfma_f32_16x16x32_bf16 v[40:43], v[208:211], v[124:127], 0
    v_mfma_f32_16x16x32_bf16 v[36:39], v[168:171], v[128:131], v[36:39]
    v_mfma_f32_16x16x32_bf16 v[40:43], v[212:215], v[128:131], v[40:43]
    v_mfma_f32_16x16x32_bf16 v[36:39], v[172:175], v[132:135], v[36:39]
    v_mfma_f32_16x16x32_bf16 v[40:43], v[216:219], v[132:135], v[40:43]
    v_mfma_f32_16x16x32_bf16 v[36:39], v[176:179], v[136:139], v[36:39]
    v_mfma_f32_16x16x32_bf16 v[40:43], v[220:223], v[136:139], v[40:43]
    v_cvt_pk_bf16_f32 v56, v44, v45
    v_cvt_pk_bf16_f32 v57, v46, v47
    ds_write_b64 v11, v[56:57] offset:13056
    v_cvt_pk_bf16_f32 v58, v48, v49
    v_cvt_pk_bf16_f32 v59, v50, v51
    ds_write_b64 v11, v[58:59] offset:13088
    s_nop 7
    v_cvt_pk_bf16_f32 v52, v36, v37
    v_cvt_pk_bf16_f32 v53, v38, v39
    ds_write_b64 v11, v[52:53] offset:17408
    v_cvt_pk_bf16_f32 v54, v40, v41
    v_cvt_pk_bf16_f32 v55, v42, v43
    ds_write_b64 v11, v[54:55] offset:17440
    s_waitcnt lgkmcnt(0)
    s_barrier
    ds_read_b128 v[124:127], v13 offset:0
    ds_read_b128 v[128:131], v13 offset:1088
    ds_read_b128 v[132:135], v13 offset:2176
    ds_read_b128 v[136:139], v13 offset:3264
    ds_read_b128 v[140:143], v13 offset:4352
    s_waitcnt lgkmcnt(4)
    buffer_store_dwordx4 v[124:127], v15, s[16:19], s52 offen offset:0 sc1
    s_waitcnt lgkmcnt(3)
    buffer_store_dwordx4 v[128:131], v15, s[16:19], s52 offen offset:1024 sc1
    s_waitcnt lgkmcnt(2)
    buffer_store_dwordx4 v[132:135], v15, s[16:19], s52 offen offset:2048 sc1
    s_waitcnt lgkmcnt(1)
    buffer_store_dwordx4 v[136:139], v15, s[16:19], s52 offen offset:3072 sc1
    s_waitcnt lgkmcnt(0)
    s_add_u32 s52, s52, 4096
    buffer_store_dwordx4 v[140:143], v15, s[16:19], s52 offen sc1
    s_endpgm
K2_b4only:
    s_lshr_b32 s50, s24, 2
    s_mul_i32 s50, s50, 80
    v_bfe_u32 v10, v1, 2, 2
    v_lshl_add_u32 v10, v10, 2, s50
    ds_read_b32 v180, v10 offset:19328
    ds_read_b32 v181, v10 offset:19344
    ds_read_b32 v182, v10 offset:19360
    ds_read_b32 v183, v10 offset:19376
    ds_read_b32 v184, v10 offset:19392
    v_and_b32 v12, 3, v1
    v_lshrrev_b32 v13, 4, v1
    v_mul_u32_u24 v15, 272, v12
    v_lshl_add_u32 v15, v13, 4, v15
    s_waitcnt lgkmcnt(0)
    v_add_u32 v180, v180, v15
    v_add_u32 v181, v181, v15
    v_add_u32 v182, v182, v15
    v_add_u32 v183, v183, v15
    v_add_u32 v184, v184, v15
    s_waitcnt vmcnt(0)
    s_barrier
    s_branch K2_loopdone
K2_empty:
    s_branch K2_loopdone
K2_slow:
    s_waitcnt vmcnt(0) lgkmcnt(0)
    s_barrier
    v_lshlrev_b32 v204, 4, v1
    s_and_b32 s51, s24, 3
    s_lshl_b32 s51, s51, 13
    s_add_u32 s51, s51, 262144
    buffer_load_dwordx4 v[164:167], v204, s[96:99], s51 offen offset:0
    buffer_load_dwordx4 v[168:171], v204, s[96:99], s51 offen offset:1024
    buffer_load_dwordx4 v[172:175], v204, s[96:99], s51 offen offset:2048
    buffer_load_dwordx4 v[176:179], v204, s[96:99], s51 offen offset:3072
    s_add_u32 s51, s51, 4096
    buffer_load_dwordx4 v[208:211], v204, s[96:99], s51 offen offset:0
    buffer_load_dwordx4 v[212:215], v204, s[96:99], s51 offen offset:1024
    buffer_load_dwordx4 v[216:219], v204, s[96:99], s51 offen offset:2048
    buffer_load_dwordx4 v[220:223], v204, s[96:99], s51 offen offset:3072
    s_mov_b32 s82, 1
    s_load_dwordx4 s[68:71], s[0:1], 8
    s_load_dwordx4 s[32:35], s[0:1], 24
    s_mov_b32 s30, 1
    s_mov_b32 s31, 0
    s_waitcnt lgkmcnt(0)
    s_mov_b64 s[96:97], s[34:35]
    s_mov_b32 s98, 10240000
    s_mov_b32 s99, 0x00020000
    s_mov_b64 s[20:21], s[32:33]
    s_mov_b32 s22, 2560000
    s_mov_b32 s23, 0x00020000
    s_branch K2_slowgo
K2_slownext:
    s_add_u32 s31, s31, 256
    s_cmp_ge_u32 s31, 320000
    s_cbranch_scc1 K2_slowfin
K2_slowgo:
    s_barrier
    v_lshlrev_b32 v12, 2, v0
    v_mov_b32 v13, 0
    v_cmp_gt_u32 vcc, 320, v0
    s_and_saveexec_b64 s[58:59], vcc
    ds_write_b32 v12, v13 offset:16384
    v_cmpx_gt_u32 vcc, 16, v0
    ds_write_b32 v12, v13 offset:19008
    s_mov_b64 exec, s[58:59]
    s_mov_b64 s[12:13], s[68:69]
    s_mov_b32 s14, 1280000
    s_mov_b32 s15, 0x00020000
    s_lshl_b32 s50, s31, 2
    v_lshlrev_b32 v11, 2, v0
    buffer_load_dword v28, v11, s[12:15], s50 offen
    s_mov_b64 s[12:13], s[70:71]
    s_mov_b32 s14, 1280000
    s_mov_b32 s15, 0x00020000
    buffer_load_dword v29, v11, s[12:15], s50 offen
    s_mov_b32 s51, 52429
    s_mov_b32 s52, 53688
    s_movk_i32 s53, -40
    v_mov_b32 v92, 1
    s_waitcnt vmcnt(0)
    v_mul_u32_u24 v30, s51, v29
    v_lshrrev_b32 v30, 21, v30
    v_mad_i32_i24 v31, v30, s53, v29
    v_mul_u32_u24 v32, s52, v28
    v_lshrrev_b32 v32, 26, v32
    v_lshl_or_b32 v32, v32, 16, v28
    v_lshl_or_b32 v32, v31, 19, v32
    v_cmp_eq_u32 vcc, s3, v30
    s_movk_i32 s54, 256
    v_cmp_gt_u32 s[58:59], s54, v0
    s_and_b64 vcc, vcc, s[58:59]
    v_mbcnt_lo_u32_b32 v33, vcc_lo, 0
    v_mbcnt_hi_u32_b32 v33, vcc_hi, v33
    s_bcnt1_i32_b64 s67, vcc
    v_add_u32 v34, s31, v0
    v_sub_u32 v34, v34, v33
    v_lshl_add_u32 v33, v33, 2, s81
    s_and_saveexec_b64 s[58:59], vcc
    ds_write_b32 v33, v34
    ds_write_b32 v33, v32 offset:1024
    s_mov_b64 exec, s[58:59]
    s_waitcnt lgkmcnt(0)
    s_barrier
    s_branch K2_round
K2_slowfin:
    s_branch K2_epi
K2_end:
    s_endpgm
.section .rodata,"a"
.p2align 6
.amdhsa_kernel bin_kernel
      .amdhsa_next_free_vgpr 112
      .amdhsa_next_free_sgpr 102
      .amdhsa_accum_offset 112
      .amdhsa_group_segment_fixed_size 0
      .amdhsa_kernarg_size 88
      .amdhsa_user_sgpr_count 2
      .amdhsa_user_sgpr_kernarg_segment_ptr 1
      .amdhsa_system_sgpr_workgroup_id_x 1
.end_amdhsa_kernel
.p2align 6
.amdhsa_kernel main_kernel
      .amdhsa_next_free_vgpr 224
      .amdhsa_next_free_sgpr 102
      .amdhsa_accum_offset 224
      .amdhsa_group_segment_fixed_size 0
      .amdhsa_kernarg_size 88
      .amdhsa_user_sgpr_count 2
      .amdhsa_user_sgpr_kernarg_segment_ptr 1
      .amdhsa_system_sgpr_workgroup_id_x 1
.end_amdhsa_kernel
```
